```python
import torch

def _softmax(x, axis=-1):
    return torch.softmax(x, dim=axis)
def _gelu(x):
    return torch.nn.functional.gelu(x, approximate="tanh")
def _silu(x):
    return torch.nn.functional.silu(x)
def _sigmoid(x):
    return torch.sigmoid(x)
def _layernorm(x, axis=-1, eps=1e-5):
    m = x.mean(dim=axis, keepdim=True)
    v = x.var(dim=axis, keepdim=True, unbiased=False)
    return (x - m) / torch.sqrt(v + eps)
def _scatter_add(tgt, idx, src, axis=0):
    return tgt.clone().index_add_(axis, idx, src)
def _segment_sum(src, seg, n):
    out = torch.zeros((n,) + src.shape[1:], dtype=src.dtype)
    return out.index_add_(0, seg, src)
def _pad(x, pw):
    flat = tuple(v for pair in reversed(pw) for v in pair)
    return torch.nn.functional.pad(x, flat)

kernel_name = 'standalone__deep_cross_wide_deep__recsys'

def setup_inputs():

    _w = (lambda a: (lambda t: t.to(torch.bfloat16) if t.is_floating_point() else t)(torch.as_tensor(a)))
    B, F, D = 16384, 100, 64
    V, Nd = min(1000, 100000), 13
    Din = F * D
    H = 4 * D
    return {
        "idx": _w((lambda lo, hi, *s: torch.randint(lo, hi, s))(0, V, B, F).to(torch.int64)),
        "table": _w((lambda *s: torch.randn(*s, dtype=torch.bfloat16) * 1.6)(V, D) * 0.05),
        "x_wide": _w((lambda *s: torch.randn(*s, dtype=torch.bfloat16) * 0.8)(B, Nd)),
        "w_wide": _w((lambda *s: torch.randn(*s, dtype=torch.bfloat16) * 0.8)(Nd) * 0.05),
        "b_wide": _w((lambda *s: torch.randn(*s, dtype=torch.bfloat16) * 0.8)(1) * 0.01),
        "W1": _w((lambda *s: torch.randn(*s, dtype=torch.bfloat16) * 1.6)(Din, H) * (2.0 / Din) ** 0.5),
        "b1": _w((lambda *s: torch.randn(*s, dtype=torch.bfloat16) * 1.6)(H) * 0.01),
        "W2": _w((lambda *s: torch.randn(*s, dtype=torch.bfloat16) * 1.6)(H) * (1.0 / H) ** 0.5),
        "b2": _w((lambda *s: torch.randn(*s, dtype=torch.bfloat16) * 1.6)(1) * 0.01),
    }

def reference(idx, table, x_wide, w_wide, b_wide, W1, b1, W2, b2):
    emb = table[idx]
    deep_in = emb.reshape(emb.shape[0], -1)
    h = deep_in @ W1 + b1
    h = h * (lambda x, dt: x.to(dt))(h > 0, h.dtype)
    deep_logit = h @ W2 + b2
    wide_logit = x_wide @ w_wide + b_wide
    return _sigmoid(wide_logit + deep_logit)
```

```asm
; @launch grid=(256,1,1) block=(512,1,1) lds=163840
.amdgcn_target "amdgcn-amd-amdhsa--gfx950"
.text
.globl standalone__deep_cross_wide_deep__recsys_kernel
.p2align 8
.type standalone__deep_cross_wide_deep__recsys_kernel,@function
standalone__deep_cross_wide_deep__recsys_kernel:
    s_cmp_ge_u32 s2, 256
    s_cbranch_scc1 M_end
    s_load_dwordx16 s[36:51], s[0:1], 0
    s_load_dwordx8 s[52:59], s[0:1], 64
    s_memrealtime s[64:65]
    s_getpc_b64 s[32:33]
C_base:
    s_lshr_b32 s29, s2, 3
    s_mul_i32 s20, s29, 1024
    v_lshl_add_u32 v255, v0, 7, s20
    v_min_u32 v255, C_end-C_base, v255
    v_cmp_gt_u32 vcc, 8, v0
    s_and_saveexec_b64 s[20:21], vcc
    s_cbranch_execz C_skip
    global_load_dword v255, v255, s[32:33]
C_skip:
    s_mov_b64 exec, -1
    v_lshrrev_b32 v66, 6, v0
    v_and_b32 v0, 63, v0
    v_lshlrev_b32 v1, 4, v0
    v_readfirstlane_b32 s22, v66
    s_bfe_u32 s24, s2, 0x10002
    s_lshl_b32 s24, s24, 1
    s_and_b32 s20, s29, 1
    s_add_u32 s24, s24, s20
    s_and_b32 s20, s2, 3
    s_lshl_b32 s20, s20, 4
    s_lshr_b32 s25, s29, 1
    s_add_u32 s25, s25, s20
    s_lshl_b32 s34, s24, 6
    s_add_u32 s34, s34, s25
    s_lshl_b32 s35, s22, 8
    s_add_u32 s35, s35, s34
    v_lshrrev_b32 v210, 4, v0
    v_and_b32 v211, 15, v0
    v_lshlrev_b32 v212, 15, v210
    v_lshl_add_u32 v212, v211, 3, v212
    v_mov_b32 v215, 0
    s_lshr_b32 s20, s35, 5
    s_lshl_b32 s20, s20, 17
    s_bfe_u32 s21, s35, 0x30002
    s_lshl_b32 s21, s21, 12
    s_add_u32 s20, s20, s21
    s_and_b32 s21, s35, 3
    s_lshl_b32 s21, s21, 7
    s_add_u32 s31, s20, s21
    s_mul_i32 s20, s34, 25600
    s_mul_i32 s21, s22, 3200
    s_add_u32 s20, s20, s21
    s_add_u32 s33, s21, 131072
    s_mov_b32 m0, s33
    s_lshl_b32 s23, s22, 13
    s_add_u32 s30, s23, 8064
    s_mov_b32 s18, 3276800
    s_mov_b32 s19, 0x00020000
    s_mov_b32 s6, 6553600
    s_mov_b32 s7, 0x00020000
    s_mov_b32 s62, 256
    s_mov_b32 s63, 0x00020000
    s_mov_b32 s14, 268435456
    s_mov_b32 s15, 0x00020000
    s_mov_b32 s10, 128000
    s_mov_b32 s11, 0x00020000
    s_mov_b32 s66, 0x05040100
    s_mov_b32 s67, 0x07060302
    s_waitcnt lgkmcnt(0)
    s_mov_b32 s16, s46
    s_and_b32 s17, s47, 0xffff
    s_mov_b32 s4, s36
    s_and_b32 s5, s37, 0xffff
    s_mov_b32 s60, s56
    s_and_b32 s61, s57, 0xffff
    s_cmp_lg_u32 s22, 6
    s_cbranch_scc1 P_n0
    s_cmp_ge_u32 s2, 8
    s_cbranch_scc1 P_n0
    v_mov_b32 v70, s64
    v_mov_b32 v71, s65
    v_mov_b32 v72, 0
    v_mov_b32 v73, 0
    v_or_b32 v71, 0x80000000, v71
    s_mov_b64 exec, 1
    buffer_atomic_cmpswap_x2 v[70:73], v72, s[60:63], 0 offen sc1
    s_mov_b64 exec, -1
    s_nop 1
P_n0:
    s_cmp_lg_u32 s22, 0
    s_cbranch_scc1 P_now1
    buffer_load_dwordx2 v[218:219], v212, s[16:19], s31 offen offset:0
    buffer_load_dwordx2 v[220:221], v212, s[16:19], s31 offen offset:512
    buffer_load_dwordx2 v[222:223], v212, s[16:19], s31 offen offset:1024
    buffer_load_dwordx2 v[224:225], v212, s[16:19], s31 offen offset:1536
    buffer_load_dwordx2 v[226:227], v212, s[16:19], s31 offen offset:2048
    buffer_load_dwordx2 v[228:229], v212, s[16:19], s31 offen offset:2560
    buffer_load_dwordx2 v[230:231], v212, s[16:19], s31 offen offset:3072
    buffer_load_dwordx2 v[232:233], v212, s[16:19], s31 offen offset:3584
P_now1:
    buffer_load_dwordx4 v1, s[4:7], s20 offen offset:0 lds
    buffer_load_dwordx4 v1, s[4:7], s20 offen offset:1024 lds
    buffer_load_dwordx4 v1, s[4:7], s20 offen offset:2048 lds
    s_mov_b64 exec, 0xff
    buffer_load_dwordx4 v1, s[4:7], s20 offen offset:3072 lds
    s_mov_b64 exec, -1
    s_mov_b32 s8, s38
    s_and_b32 s9, s39, 0xffff
    s_mov_b32 s12, s58
    s_and_b32 s13, s59, 0xffff
    s_barrier
    s_cmp_lg_u32 s22, 5
    s_cbranch_scc1 P_n5
    s_load_dword s74, s[56:57], 192
P_n5:
    s_cmp_lt_u32 s22, 4
    s_cbranch_scc1 P_lo
    s_cmp_lg_u32 s22, 4
    s_cbranch_scc1 P_skip
    v_and_b32 v255, 31, v0
    v_lshlrev_b32 v255, 7, v255
    s_lshl_b32 s21, s29, 12
    buffer_load_dword v255, v255, s[8:11], s21 offen
    s_branch P_skip
P_lo:
    s_cmp_ge_u32 s35, 800
    s_cbranch_scc1 P_skip
    s_add_u32 s21, s23, 0x10000
    v_mul_u32_u24 v213, 272, v211
    v_lshl_add_u32 v213, v210, 5, v213
    v_add_u32 v213, s21, v213
    v_mul_u32_u24 v214, 272, v210
    v_lshl_add_u32 v214, v211, 4, v214
    v_add_u32 v214, s21, v214
    v_lshlrev_b32 v215, 16, v210
    v_bfe_u32 v216, v0, 3, 1
    v_lshl_add_u32 v215, v216, 12, v215
    v_and_b32 v216, 7, v0
    v_lshl_add_u32 v215, v216, 4, v215
    s_and_b32 s26, s35, 3
    s_lshl_b32 s26, s26, 20
    s_lshr_b32 s21, s35, 7
    s_lshl_b32 s21, s21, 13
    s_add_u32 s26, s26, s21
    s_bfe_u32 s21, s35, 0x30002
    s_lshl_b32 s21, s21, 9
    s_add_u32 s26, s26, s21
    s_bfe_u32 s21, s35, 0x20005
    s_lshl_b32 s21, s21, 7
    s_add_u32 s26, s26, s21
    s_add_u32 s26, s26, 4194304
    s_and_b32 s75, s35, 3
    s_lshl_b32 s75, s75, 11
    s_bfe_u32 s21, s35, 0x20003
    s_lshl_b32 s21, s21, 9
    s_add_u32 s75, s75, s21
    s_lshr_b32 s21, s35, 5
    s_lshl_b32 s21, s21, 4
    s_add_u32 s75, s75, s21
    s_bfe_u32 s21, s35, 0x10002
    s_lshl_b32 s21, s21, 3
    s_add_u32 s75, s75, s21
    s_add_u32 s75, s75, 16793600
    s_cmp_ge_u32 s22, 2
    s_cbranch_scc1 P_skip
    s_and_b32 s75, s35, 3
    s_lshl_b32 s75, s75, 14
    s_lshr_b32 s21, s35, 7
    s_lshl_b32 s21, s21, 12
    s_add_u32 s75, s75, s21
    s_bfe_u32 s21, s35, 0x20003
    s_lshl_b32 s21, s21, 10
    s_add_u32 s75, s75, s21
    s_bfe_u32 s21, s35, 0x20005
    s_lshl_b32 s21, s21, 8
    s_add_u32 s75, s75, s21
    s_bfe_u32 s21, s35, 0x10002
    s_lshl_b32 s21, s21, 7
    s_add_u32 s75, s75, s21
    s_add_u32 s75, s75, 16842752
    s_cmp_lg_u32 s22, 0
    s_cbranch_scc1 P_skip
P_e0:
    s_waitcnt vmcnt(4)
    v_perm_b32 v130, v220, v218, s66
    v_perm_b32 v131, v224, v222, s66
    v_perm_b32 v132, v228, v226, s66
    v_perm_b32 v133, v232, v230, s66
    v_perm_b32 v134, v220, v218, s67
    v_perm_b32 v135, v224, v222, s67
    v_perm_b32 v136, v228, v226, s67
    v_perm_b32 v137, v232, v230, s67
    v_perm_b32 v138, v221, v219, s66
    v_perm_b32 v139, v225, v223, s66
    v_perm_b32 v140, v229, v227, s66
    v_perm_b32 v141, v233, v231, s66
    v_perm_b32 v142, v221, v219, s67
    v_perm_b32 v143, v225, v223, s67
    v_perm_b32 v144, v229, v227, s67
    v_perm_b32 v145, v233, v231, s67
    ds_write_b128 v213, v[130:133] offset:0
    ds_write_b128 v213, v[134:137] offset:128
    ds_write_b128 v213, v[138:141] offset:16
    ds_write_b128 v213, v[142:145] offset:144
    s_waitcnt lgkmcnt(0)
    ds_read_b128 v[146:149], v214 offset:0
    ds_read_b128 v[150:153], v214 offset:1088
    ds_read_b128 v[154:157], v214 offset:2176
    ds_read_b128 v[158:161], v214 offset:3264
    s_waitcnt lgkmcnt(3)
    buffer_store_dwordx4 v[146:149], v215, s[12:15], s26 offen sc1
    s_add_u32 s26, s26, 262144
    s_waitcnt lgkmcnt(2)
    buffer_store_dwordx4 v[150:153], v215, s[12:15], s26 offen sc1
    s_add_u32 s26, s26, 262144
    s_waitcnt lgkmcnt(1)
    buffer_store_dwordx4 v[154:157], v215, s[12:15], s26 offen sc1
    s_add_u32 s26, s26, 262144
    s_waitcnt lgkmcnt(0)
    buffer_store_dwordx4 v[158:161], v215, s[12:15], s26 offen sc1
    s_add_u32 s26, s26, 262144
    s_load_dwordx2 s[64:65], s[56:57], 0
P_skip:
    v_and_b32 v70, 7, v0
    v_lshrrev_b32 v71, 3, v0
    s_and_b32 s20, s34, 1
    s_lshl_b32 s20, s20, 3
    v_add_u32 v72, s20, v70
    v_mul_u32_u24 v73, 400, v70
    v_add_u32 v73, s33, v73
    v_and_b32 v74, 1, v71
    v_lshrrev_b32 v75, 1, v71
    v_lshlrev_b32 v76, 3, v74
    v_xor_b32 v76, v76, v72
    v_lshl_add_u32 v77, v75, 6, v73
    v_lshlrev_b32 v75, 14, v75
    v_lshl_add_u32 v75, v74, 10, v75
    v_lshl_add_u32 v75, v70, 4, v75
    v_xor_b32 v78, 0, v76
    v_lshl_add_u32 v86, v78, 2, v77
    v_xor_b32 v79, 1, v76
    v_lshl_add_u32 v87, v79, 2, v77
    v_xor_b32 v80, 2, v76
    v_lshl_add_u32 v88, v80, 2, v77
    v_xor_b32 v81, 3, v76
    v_lshl_add_u32 v89, v81, 2, v77
    v_xor_b32 v82, 4, v76
    v_lshl_add_u32 v90, v82, 2, v77
    v_xor_b32 v83, 5, v76
    v_lshl_add_u32 v91, v83, 2, v77
    v_xor_b32 v84, 6, v76
    v_lshl_add_u32 v92, v84, 2, v77
    v_xor_b32 v85, 7, v76
    v_lshl_add_u32 v93, v85, 2, v77
    v_and_b32 v76, 3, v70
    v_xor_b32 v118, 0, v76
    v_lshl_add_u32 v122, v118, 2, v73
    v_add_u32 v118, 16384, v118
    v_xor_b32 v119, 1, v76
    v_lshl_add_u32 v123, v119, 2, v73
    v_add_u32 v119, 16384, v119
    v_xor_b32 v120, 2, v76
    v_lshl_add_u32 v124, v120, 2, v73
    v_add_u32 v120, 16384, v120
    v_xor_b32 v121, 3, v76
    v_lshl_add_u32 v125, v121, 2, v73
    v_add_u32 v121, 16384, v121
    s_lshr_b32 s27, s34, 3
    s_mul_i32 s27, s27, 102400
    s_lshl_b32 s20, s22, 11
    s_add_u32 s28, s27, s20
    s_and_b32 s21, s34, 7
    s_lshl_b32 s20, s21, 7
    s_add_u32 s28, s28, s20
    s_lshl_b32 s20, s22, 9
    s_add_u32 s27, s27, s20
    s_lshl_b32 s20, s21, 6
    s_add_u32 s27, s27, s20
    s_add_u32 s27, s27, 98304
    v_lshlrev_b32 v74, 3, v70
    v_xor_b32 v163, v70, v210
    v_lshlrev_b32 v162, 7, v71
    v_lshl_add_u32 v162, v163, 4, v162
    v_xor_b32 v163, 64, v162
    s_cmp_lt_u32 s22, 4
    s_cbranch_scc1 P_np
    s_add_u32 s21, s23, 65536
    s_mov_b32 m0, s21
    s_nop 0
    buffer_load_dwordx4 v162, s[8:11], s21 offen offset:0 lds
    buffer_load_dwordx4 v163, s[8:11], s21 offen offset:1024 lds
    buffer_load_dwordx4 v162, s[8:11], s21 offen offset:2048 lds
    buffer_load_dwordx4 v163, s[8:11], s21 offen offset:3072 lds
    s_add_u32 s21, s23, 69632
    s_mov_b32 m0, s21
    s_nop 0
    buffer_load_dwordx4 v162, s[8:11], s21 offen offset:0 lds
    buffer_load_dwordx4 v163, s[8:11], s21 offen offset:1024 lds
    buffer_load_dwordx4 v162, s[8:11], s21 offen offset:2048 lds
    buffer_load_dwordx4 v163, s[8:11], s21 offen offset:3072 lds
    s_waitcnt vmcnt(8)
    s_branch P_c9
P_np:
    s_cmp_lg_u32 s22, 0
    s_cbranch_scc1 P_c0
    s_waitcnt lgkmcnt(0)
    s_cmp_lt_i32 s65, 0
    s_cbranch_scc1 N_1ok
    s_mov_b32 s20, 0
    v_mov_b32 v246, 0
N_1:
    buffer_load_dwordx2 v[248:249], v246, s[60:63], 0 offen sc1
    s_add_u32 s20, s20, 1
    s_waitcnt vmcnt(0)
    v_readfirstlane_b32 s64, v248
    v_readfirstlane_b32 s65, v249
    s_cmp_lt_i32 s65, 0
    s_cbranch_scc1 N_1ok
    s_sleep 1
    s_cmp_lt_u32 s20, 0x8000
    s_cbranch_scc1 N_1
N_1ok:
    v_mov_b32 v246, s64
    v_mov_b32 v247, s65
    v_mov_b32 v248, s64
    v_mov_b32 v249, s65
    s_mov_b64 exec, 0xff
    s_waitcnt vmcnt(0)
    buffer_store_dwordx4 v[246:249], v1, s[12:15], s75 offen sc1
    s_mov_b64 exec, -1
    s_mov_b32 s35, 4097
    s_branch P_c9
P_c0:
    s_waitcnt vmcnt(0)
P_c9:
    ds_read_b32 v94, v86
    ds_read_b32 v95, v87
    ds_read_b32 v96, v88
    ds_read_b32 v97, v89
    ds_read_b32 v98, v90
    ds_read_b32 v99, v91
    ds_read_b32 v100, v92
    ds_read_b32 v101, v93
    ds_read_b32 v102, v86 offset:256
    ds_read_b32 v103, v87 offset:256
    ds_read_b32 v104, v88 offset:256
    ds_read_b32 v105, v89 offset:256
    ds_read_b32 v106, v90 offset:256
    ds_read_b32 v107, v91 offset:256
    ds_read_b32 v108, v92 offset:256
    ds_read_b32 v109, v93 offset:256
    ds_read_b32 v126, v122 offset:384
    ds_read_b32 v127, v123 offset:384
    ds_read_b32 v128, v124 offset:384
    ds_read_b32 v129, v125 offset:384
    s_waitcnt lgkmcnt(12)
    v_lshl_add_u32 v94, v94, 4, v78
    v_lshl_add_u32 v95, v95, 4, v79
    v_lshl_add_u32 v96, v96, 4, v80
    v_lshl_add_u32 v97, v97, 4, v81
    v_lshl_add_u32 v98, v98, 4, v82
    v_lshl_add_u32 v99, v99, 4, v83
    v_lshl_add_u32 v100, v100, 4, v84
    v_lshl_add_u32 v101, v101, 4, v85
    v_lshl_or_b32 v110, v95, 16, v94
    v_lshl_or_b32 v111, v97, 16, v96
    v_lshl_or_b32 v112, v99, 16, v98
    v_lshl_or_b32 v113, v101, 16, v100
    buffer_store_dwordx4 v[110:113], v75, s[12:15], s28 offen sc1
    s_waitcnt lgkmcnt(0)
    s_load_dwordx2 s[64:65], s[56:57], 0
    s_lshl_b32 s20, s25, 3
    s_add_u32 s48, s48, s20
    s_addc_u32 s49, s49, 0
    s_add_u32 s50, s50, s20
    s_addc_u32 s51, s51, 0
    s_load_dwordx2 s[70:71], s[48:49], 0
    s_load_dwordx2 s[72:73], s[50:51], 0
    v_lshl_add_u32 v102, v102, 4, v78
    v_lshl_add_u32 v103, v103, 4, v79
    v_lshl_add_u32 v104, v104, 4, v80
    v_lshl_add_u32 v105, v105, 4, v81
    v_lshl_add_u32 v106, v106, 4, v82
    v_lshl_add_u32 v107, v107, 4, v83
    v_lshl_add_u32 v108, v108, 4, v84
    v_lshl_add_u32 v109, v109, 4, v85
    v_lshl_or_b32 v114, v103, 16, v102
    v_lshl_or_b32 v115, v105, 16, v104
    v_lshl_or_b32 v116, v107, 16, v106
    v_lshl_or_b32 v117, v109, 16, v108
    v_lshrrev_b32 v122, 1, v126
    v_lshl_add_u32 v126, v126, 2, v118
    v_and_b32 v122, 2, v122
    v_xor_b32 v126, v126, v122
    v_lshrrev_b32 v123, 1, v127
    v_lshl_add_u32 v127, v127, 2, v119
    v_and_b32 v123, 2, v123
    v_xor_b32 v127, v127, v123
    v_lshrrev_b32 v124, 1, v128
    v_lshl_add_u32 v128, v128, 2, v120
    v_and_b32 v124, 2, v124
    v_xor_b32 v128, v128, v124
    v_lshrrev_b32 v125, 1, v129
    v_lshl_add_u32 v129, v129, 2, v121
    v_and_b32 v125, 2, v125
    v_xor_b32 v129, v129, v125
    v_lshl_or_b32 v122, v127, 16, v126
    v_lshl_or_b32 v123, v129, 16, v128
    s_add_u32 s28, s28, 65536
    s_mov_b32 exec_hi, 0
    buffer_store_dwordx4 v[114:117], v75, s[12:15], s28 offen sc1
    s_mov_b64 exec, 0xff
    buffer_store_dwordx2 v[122:123], v74, s[12:15], s27 offen sc1
    s_mov_b64 exec, -1
    s_mov_b32 s36, s31
    s_mov_b32 s37, s26
    s_mov_b32 s38, s75
    s_add_u32 s27, s23, 0
    s_mov_b32 m0, s27
    s_nop 0
    buffer_load_dwordx4 v162, s[8:11], s27 offen offset:0 lds
    buffer_load_dwordx4 v163, s[8:11], s27 offen offset:1024 lds
    buffer_load_dwordx4 v162, s[8:11], s27 offen offset:2048 lds
    buffer_load_dwordx4 v163, s[8:11], s27 offen offset:3072 lds
    s_waitcnt lgkmcnt(0)
    s_cmp_lt_i32 s65, 0
    s_cbranch_scc1 N_2ok
    s_mov_b32 s20, 0
    v_mov_b32 v246, 0
N_2:
    buffer_load_dwordx2 v[248:249], v246, s[60:63], 0 offen sc1
    s_add_u32 s20, s20, 1
    s_waitcnt vmcnt(0)
    v_readfirstlane_b32 s64, v248
    v_readfirstlane_b32 s65, v249
    s_cmp_lt_i32 s65, 0
    s_cbranch_scc1 N_2ok
    s_sleep 1
    s_cmp_lt_u32 s20, 0x8000
    s_cbranch_scc1 N_2
N_2ok:
    s_lshr_b32 s31, s34, 3
    s_lshl_b32 s31, s31, 9
    s_and_b32 s20, s34, 7
    s_lshl_b32 s20, s20, 6
    s_add_u32 s31, s31, s20
    s_lshl_b32 s20, s22, 3
    s_add_u32 s31, s31, s20
    s_add_u32 s31, s31, 16777216
    s_waitcnt vmcnt(0)
    v_mov_b32 v248, 0
    v_mov_b32 v246, s64
    v_mov_b32 v247, s65
    s_mov_b64 exec, 1
    buffer_store_dwordx2 v[246:247], v248, s[12:15], s31 offen sc1
    s_mov_b64 exec, -1
    s_lshr_b32 s20, s22, 2
    s_add_u32 s20, s20, 1
    s_lshl_b32 s20, s20, 8
    s_add_u32 s20, s20, s34
    s_lshr_b32 s21, s20, 5
    s_lshl_b32 s21, s21, 17
    s_bfe_u32 s39, s20, 0x30002
    s_lshl_b32 s39, s39, 12
    s_add_u32 s21, s21, s39
    s_and_b32 s39, s20, 3
    s_lshl_b32 s39, s39, 7
    s_add_u32 s21, s21, s39
    s_and_b32 s39, s22, 3
    s_lshl_b32 s39, s39, 10
    s_add_u32 s21, s21, s39
    s_add_u32 s46, s46, s21
    s_addc_u32 s47, s47, 0
    s_load_dword s3, s[46:47], 0
    s_load_dword s3, s[46:47], 512
    s_load_dword s3, s[46:47], 32768
    s_load_dword s3, s[46:47], 33280
    s_load_dword s3, s[46:47], 65536
    s_load_dword s3, s[46:47], 66048
    s_load_dword s3, s[46:47], 98304
    s_load_dword s3, s[46:47], 98816
    s_cmp_lt_u32 s22, 4
    s_cbranch_scc1 P_g
    s_and_b32 s21, s24, 1
    s_lshr_b32 s68, s25, 4
    s_lshl_b32 s68, s68, 14
    s_lshl_b32 s20, s21, 12
    s_add_u32 s68, s68, s20
    s_and_b32 s20, s22, 3
    s_lshl_b32 s20, s20, 10
    s_add_u32 s68, s68, s20
    s_add_u32 s68, s68, 16842752
    s_lshl_b32 s69, s25, 16
    s_lshl_b32 s21, s21, 13
    s_add_u32 s69, s69, s21
    s_add_u32 s69, s69, s20
    s_add_u32 s69, s69, 4194304
    s_add_u32 s74, s69, 4096
    v_and_b32 v242, 7, v0
    v_lshlrev_b32 v242, 7, v242
    buffer_load_dwordx2 v[244:245], v242, s[12:15], s68 offen sc1
    s_add_u32 s27, s23, 4096
    s_mov_b32 m0, s27
    s_nop 0
    buffer_load_dwordx4 v162, s[8:11], s27 offen offset:0 lds
    buffer_load_dwordx4 v163, s[8:11], s27 offen offset:1024 lds
    buffer_load_dwordx4 v162, s[8:11], s27 offen offset:2048 lds
    buffer_load_dwordx4 v163, s[8:11], s27 offen offset:3072 lds
    s_mov_b32 s20, 0
    s_waitcnt vmcnt(4)
Q_3:
    v_cmp_ne_u64 vcc, s[64:65], v[244:245]
    s_cbranch_vccz Q_3ok
    s_sleep 1
    buffer_load_dwordx2 v[244:245], v242, s[12:15], s68 offen sc1
    s_add_u32 s20, s20, 1
    s_waitcnt vmcnt(0)
    s_cmp_lt_u32 s20, 0x8000
    s_cbranch_scc1 Q_3
Q_3ok:
    buffer_load_dwordx4 v[234:237], v1, s[12:15], s69 offen sc1
    buffer_load_dwordx4 v[238:241], v1, s[12:15], s74 offen sc1
    s_branch P_e
P_g:
    s_add_u32 s27, s23, 4096
    s_mov_b32 m0, s27
    s_nop 0
    buffer_load_dwordx4 v162, s[8:11], s27 offen offset:0 lds
    buffer_load_dwordx4 v163, s[8:11], s27 offen offset:1024 lds
    buffer_load_dwordx4 v162, s[8:11], s27 offen offset:2048 lds
    buffer_load_dwordx4 v163, s[8:11], s27 offen offset:3072 lds
    s_add_u32 s27, s23, 65536
    s_mov_b32 m0, s27
    s_nop 0
    buffer_load_dwordx4 v162, s[8:11], s27 offen offset:0 lds
    buffer_load_dwordx4 v163, s[8:11], s27 offen offset:1024 lds
    buffer_load_dwordx4 v162, s[8:11], s27 offen offset:2048 lds
    buffer_load_dwordx4 v163, s[8:11], s27 offen offset:3072 lds
    s_add_u32 s27, s23, 69632
    s_mov_b32 m0, s27
    s_nop 0
    buffer_load_dwordx4 v162, s[8:11], s27 offen offset:0 lds
    buffer_load_dwordx4 v163, s[8:11], s27 offen offset:1024 lds
    buffer_load_dwordx4 v162, s[8:11], s27 offen offset:2048 lds
    buffer_load_dwordx4 v163, s[8:11], s27 offen offset:3072 lds
P_e:
    v_bfe_u32 v68, v0, 4, 1
    v_lshlrev_b32 v68, 1, v68
    v_bfe_u32 v66, v0, 2, 2
    v_mov_b32 v67, 0x3f80
    v_cmp_eq_u32 vcc, v68, v66
    v_add_u32 v68, 1, v68
    s_nop 0
    v_cndmask_b32 v250, 0, v67, vcc
    v_cmp_eq_u32 vcc, v68, v66
    v_mov_b32 v251, v250
    v_and_b32 v68, 3, v0
    v_cndmask_b32 v252, 0, v67, vcc
    v_mul_u32_u24 v254, 0x5555, v68
    v_mov_b32 v253, v252
    v_and_b32 v69, 24, v0
    v_and_b32 v66, 3, v0
    v_lshl_add_u32 v69, v66, 1, v69
    v_bfe_u32 v66, v0, 2, 1
    v_add_u32 v69, v69, v66
    v_lshrrev_b32 v66, 5, v0
    v_bfe_u32 v67, v69, 1, 3
    v_xor_b32 v67, v67, v66
    v_lshlrev_b32 v69, 7, v69
    v_lshl_add_u32 v69, v67, 4, v69
    v_add_u32 v166, s23, v69
    v_xor_b32 v167, 32, v166
    v_xor_b32 v168, 64, v166
    v_xor_b32 v169, 96, v166
    v_add_u32 v170, 0x10000, v166
    v_add_u32 v171, 0x10000, v167
    v_add_u32 v172, 0x10000, v168
    v_add_u32 v173, 0x10000, v169
    v_add_u32 v174, s33, v1
    v_add_u32 v175, 131072, v1
    v_lshlrev_b32 v246, 3, v0
    s_and_b32 s21, s24, 1
    s_xor_b32 s20, s24, 1
    s_lshl_b32 s28, s20, 3
    s_add_u32 s28, s28, s22
    s_mul_i32 s28, s28, 102400
    s_lshl_b32 s27, s21, 14
    s_add_u32 s28, s28, s27
    s_lshl_b32 s68, s20, 3
    s_add_u32 s68, s68, s22
    s_lshl_b32 s68, s68, 9
    s_add_u32 s68, s68, 16777216
    s_xor_b32 s31, s68, 4096
    s_lshl_b32 s75, s24, 6
    s_lshl_b32 s27, s22, 3
    s_add_u32 s75, s75, s27
    s_lshl_b32 s75, s75, 6
    s_add_u32 s75, s75, s25
    s_lshl_b32 s75, s75, 8
    s_add_u32 s75, s75, 8388608
    s_lshr_b32 s29, s25, 4
    s_lshl_b32 s39, s29, 14
    s_lshl_b32 s29, s29, 11
    s_and_b32 s27, s22, 3
    s_lshl_b32 s27, s27, 9
    s_add_u32 s29, s29, s27
    s_add_u32 s29, s29, 16793856
    s_lshl_b32 s27, s27, 1
    s_add_u32 s39, s39, s27
    s_lshl_b32 s27, s21, 12
    s_add_u32 s39, s39, s27
    s_add_u32 s39, s39, 16850944
    s_lshl_b32 s26, s25, 16
    s_lshl_b32 s27, s22, 10
    s_add_u32 s26, s26, s27
    s_lshl_b32 s27, s21, 13
    s_add_u32 s26, s26, s27
    s_add_u32 s26, s26, 4210688
    s_lshl_b32 s48, s70, 16
    s_and_b32 s49, s70, 0xffff0000
    s_lshl_b32 s50, s71, 16
    s_and_b32 s51, s71, 0xffff0000
    v_mov_b64 v[66:67], 0
    v_mov_b64 v[68:69], 0
    v_mov_b64 v[70:71], 0
    v_mov_b64 v[72:73], 0
    v_mov_b64 v[74:75], 0
    v_mov_b64 v[76:77], 0
    v_mov_b64 v[78:79], 0
    v_mov_b64 v[80:81], 0
    v_mov_b64 v[82:83], 0
    v_mov_b64 v[84:85], 0
    v_mov_b64 v[86:87], 0
    v_mov_b64 v[88:89], 0
    v_mov_b64 v[90:91], 0
    v_mov_b64 v[92:93], 0
    v_mov_b64 v[94:95], 0
    v_mov_b64 v[96:97], 0
    v_mov_b64 v[98:99], s[48:49]
    v_mov_b64 v[100:101], s[50:51]
    v_mov_b64 v[102:103], s[48:49]
    v_mov_b64 v[104:105], s[50:51]
    v_mov_b64 v[106:107], s[48:49]
    v_mov_b64 v[108:109], s[50:51]
    v_mov_b64 v[110:111], s[48:49]
    v_mov_b64 v[112:113], s[50:51]
    v_mov_b64 v[114:115], s[48:49]
    v_mov_b64 v[116:117], s[50:51]
    v_mov_b64 v[118:119], s[48:49]
    v_mov_b64 v[120:121], s[50:51]
    v_mov_b64 v[122:123], s[48:49]
    v_mov_b64 v[124:125], s[50:51]
    v_mov_b64 v[126:127], s[48:49]
    v_mov_b64 v[128:129], s[50:51]
    s_waitcnt vmcnt(0)
    s_cmp_lt_u32 s22, 4
    s_cbranch_scc1 P_h
    ds_write_b128 v174, v[234:237] offset:1024
    ds_write_b128 v174, v[238:241] offset:2048
P_h:
    ds_read_b128 v[2:5], v166 offset:0
    ds_read_b128 v[6:9], v167 offset:0
    ds_read_b128 v[10:13], v168 offset:0
    ds_read_b128 v[14:17], v169 offset:0
    ds_read_b128 v[18:21], v166 offset:4096
    ds_read_b128 v[22:25], v167 offset:4096
    ds_read_b128 v[26:29], v168 offset:4096
    ds_read_b128 v[30:33], v169 offset:4096
    ds_read_b128 v[34:37], v170 offset:0
    ds_read_b128 v[38:41], v171 offset:0
    ds_read_b128 v[42:45], v172 offset:0
    ds_read_b128 v[46:49], v173 offset:0
    ds_read_b128 v[50:53], v170 offset:4096
    ds_read_b128 v[54:57], v171 offset:4096
    ds_read_b128 v[58:61], v172 offset:4096
    ds_read_b128 v[62:65], v173 offset:4096
    v_mov_b32 v176, 163836
    v_mov_b32 v177, 0
    ds_write_b32 v176, v177
    s_waitcnt lgkmcnt(0)
    s_barrier
    ds_read_b128 v[130:133], v175 offset:13824
    ds_read_b128 v[146:149], v175 offset:14848
    ds_read_b128 v[134:137], v175 offset:17024
    ds_read_b128 v[150:153], v175 offset:18048
    ds_read_b128 v[138:141], v175 offset:20224
    ds_read_b128 v[154:157], v175 offset:21248
    ds_read_b128 v[142:145], v175 offset:23424
    ds_read_b128 v[158:161], v175 offset:24448
    buffer_load_dwordx2 v[234:235], v246, s[12:15], s68 offen sc1
    buffer_load_dwordx2 v[236:237], v246, s[12:15], s31 offen sc1
    s_cmp_ge_u32 s35, 800
    s_cbranch_scc1 P_u0
    buffer_load_dwordx2 v[218:219], v212, s[16:19], s36 offen offset:0
    buffer_load_dwordx2 v[220:221], v212, s[16:19], s36 offen offset:512
    buffer_load_dwordx2 v[222:223], v212, s[16:19], s36 offen offset:1024
    buffer_load_dwordx2 v[224:225], v212, s[16:19], s36 offen offset:1536
    buffer_load_dwordx2 v[226:227], v212, s[16:19], s36 offen offset:2048
    buffer_load_dwordx2 v[228:229], v212, s[16:19], s36 offen offset:2560
    buffer_load_dwordx2 v[230:231], v212, s[16:19], s36 offen offset:3072
    buffer_load_dwordx2 v[232:233], v212, s[16:19], s36 offen offset:3584
P_u0:
    s_and_b32 s21, s24, 1
    s_lshl_b32 s21, s21, 1
    s_sub_u32 s21, s21, 1
    s_mul_i32 s46, s21, 819200
    s_sub_u32 s47, 16384, s46
    s_sub_u32 s46, s46, 16384
    s_mov_b32 m0, s23
    s_waitcnt lgkmcnt(7)
    v_mfma_f32_32x32x16_bf16 v[178:193], v[2:5], v[130:133], 0
    s_waitcnt lgkmcnt(6)
    v_mfma_f32_32x32x16_bf16 v[194:209], v[2:5], v[146:149], 0
    s_waitcnt lgkmcnt(5)
    v_mfma_f32_32x32x16_bf16 v[178:193], v[6:9], v[134:137], v[178:193]
    s_waitcnt lgkmcnt(4)
    v_mfma_f32_32x32x16_bf16 v[194:209], v[6:9], v[150:153], v[194:209]
    s_waitcnt lgkmcnt(3)
    v_mfma_f32_32x32x16_bf16 v[178:193], v[10:13], v[138:141], v[178:193]
    s_waitcnt lgkmcnt(2)
    v_mfma_f32_32x32x16_bf16 v[194:209], v[10:13], v[154:157], v[194:209]
    s_waitcnt lgkmcnt(1)
    v_mfma_f32_32x32x16_bf16 v[178:193], v[14:17], v[142:145], v[178:193]
    s_waitcnt lgkmcnt(0)
    v_mfma_f32_32x32x16_bf16 v[194:209], v[14:17], v[158:161], v[194:209]
    s_nop 11
    v_cvt_pk_bf16_f32 v178, v178, v194
    v_cvt_pk_bf16_f32 v179, v179, v195
    ds_write_addtid_b32 v178 offset:0
    v_cvt_pk_bf16_f32 v180, v180, v196
    ds_write_addtid_b32 v179 offset:256
    v_cvt_pk_bf16_f32 v181, v181, v197
    ds_write_addtid_b32 v180 offset:512
    v_cvt_pk_bf16_f32 v182, v182, v198
    ds_write_addtid_b32 v181 offset:768
    v_cvt_pk_bf16_f32 v183, v183, v199
    ds_write_addtid_b32 v182 offset:1024
    v_cvt_pk_bf16_f32 v184, v184, v200
    ds_write_addtid_b32 v183 offset:1280
    v_cvt_pk_bf16_f32 v185, v185, v201
    ds_write_addtid_b32 v184 offset:1536
    v_cvt_pk_bf16_f32 v186, v186, v202
    ds_write_addtid_b32 v185 offset:1792
    v_cvt_pk_bf16_f32 v187, v187, v203
    ds_write_addtid_b32 v186 offset:2048
    v_cvt_pk_bf16_f32 v188, v188, v204
    ds_write_addtid_b32 v187 offset:2304
    v_cvt_pk_bf16_f32 v189, v189, v205
    ds_write_addtid_b32 v188 offset:2560
    v_cvt_pk_bf16_f32 v190, v190, v206
    ds_write_addtid_b32 v189 offset:2816
    v_cvt_pk_bf16_f32 v191, v191, v207
    ds_write_addtid_b32 v190 offset:3072
    v_cvt_pk_bf16_f32 v192, v192, v208
    ds_write_addtid_b32 v191 offset:3328
    v_cvt_pk_bf16_f32 v193, v193, v209
    ds_write_addtid_b32 v192 offset:3584
    ds_write_addtid_b32 v193 offset:3840
    v_mfma_f32_32x32x16_bf16 v[178:193], v[18:21], v[130:133], 0
    v_mfma_f32_32x32x16_bf16 v[194:209], v[18:21], v[146:149], 0
    v_mfma_f32_32x32x16_bf16 v[178:193], v[22:25], v[134:137], v[178:193]
    v_mfma_f32_32x32x16_bf16 v[194:209], v[22:25], v[150:153], v[194:209]
    v_mfma_f32_32x32x16_bf16 v[178:193], v[26:29], v[138:141], v[178:193]
    v_mfma_f32_32x32x16_bf16 v[194:209], v[26:29], v[154:157], v[194:209]
    v_mfma_f32_32x32x16_bf16 v[178:193], v[30:33], v[142:145], v[178:193]
    v_mfma_f32_32x32x16_bf16 v[194:209], v[30:33], v[158:161], v[194:209]
    s_nop 11
    v_cvt_pk_bf16_f32 v178, v178, v194
    v_cvt_pk_bf16_f32 v179, v179, v195
    ds_write_addtid_b32 v178 offset:4096
    v_cvt_pk_bf16_f32 v180, v180, v196
    ds_write_addtid_b32 v179 offset:4352
    v_cvt_pk_bf16_f32 v181, v181, v197
    ds_write_addtid_b32 v180 offset:4608
    v_cvt_pk_bf16_f32 v182, v182, v198
    ds_write_addtid_b32 v181 offset:4864
    v_cvt_pk_bf16_f32 v183, v183, v199
    ds_write_addtid_b32 v182 offset:5120
    v_cvt_pk_bf16_f32 v184, v184, v200
    ds_write_addtid_b32 v183 offset:5376
    v_cvt_pk_bf16_f32 v185, v185, v201
    ds_write_addtid_b32 v184 offset:5632
    v_cvt_pk_bf16_f32 v186, v186, v202
    ds_write_addtid_b32 v185 offset:5888
    v_cvt_pk_bf16_f32 v187, v187, v203
    ds_write_addtid_b32 v186 offset:6144
    v_cvt_pk_bf16_f32 v188, v188, v204
    ds_write_addtid_b32 v187 offset:6400
    v_cvt_pk_bf16_f32 v189, v189, v205
    ds_write_addtid_b32 v188 offset:6656
    v_cvt_pk_bf16_f32 v190, v190, v206
    ds_write_addtid_b32 v189 offset:6912
    v_cvt_pk_bf16_f32 v191, v191, v207
    ds_write_addtid_b32 v190 offset:7168
    v_cvt_pk_bf16_f32 v192, v192, v208
    ds_write_addtid_b32 v191 offset:7424
    v_cvt_pk_bf16_f32 v193, v193, v209
    ds_write_addtid_b32 v192 offset:7680
    ds_write_addtid_b32 v193 offset:7936
    s_cmp_ge_u32 s35, 800
    s_cbranch_scc1 P_k2
    s_waitcnt vmcnt(0)
    v_perm_b32 v162, v220, v218, s66
    v_perm_b32 v163, v224, v222, s66
    v_perm_b32 v164, v228, v226, s66
    v_perm_b32 v165, v232, v230, s66
    v_perm_b32 v166, v220, v218, s67
    v_perm_b32 v167, v224, v222, s67
    v_perm_b32 v168, v228, v226, s67
    v_perm_b32 v169, v232, v230, s67
    v_perm_b32 v170, v221, v219, s66
    v_perm_b32 v171, v225, v223, s66
    v_perm_b32 v172, v229, v227, s66
    v_perm_b32 v173, v233, v231, s66
    v_perm_b32 v174, v221, v219, s67
    v_perm_b32 v175, v225, v223, s67
    v_perm_b32 v176, v229, v227, s67
    v_perm_b32 v177, v233, v231, s67
    ds_write_b128 v213, v[162:165] offset:0
    ds_write_b128 v213, v[166:169] offset:128
    ds_write_b128 v213, v[170:173] offset:16
    ds_write_b128 v213, v[174:177] offset:144
    s_waitcnt lgkmcnt(0)
    ds_read_b128 v[218:221], v214 offset:0
    ds_read_b128 v[222:225], v214 offset:1088
    ds_read_b128 v[226:229], v214 offset:2176
    ds_read_b128 v[230:233], v214 offset:3264
    s_waitcnt lgkmcnt(3)
    buffer_store_dwordx4 v[218:221], v215, s[12:15], s37 offen sc1
    s_add_u32 s37, s37, 262144
    s_waitcnt lgkmcnt(2)
    buffer_store_dwordx4 v[222:225], v215, s[12:15], s37 offen sc1
    s_add_u32 s37, s37, 262144
    s_waitcnt lgkmcnt(1)
    buffer_store_dwordx4 v[226:229], v215, s[12:15], s37 offen sc1
    s_add_u32 s37, s37, 262144
    s_waitcnt lgkmcnt(0)
    buffer_store_dwordx4 v[230:233], v215, s[12:15], s37 offen sc1
    s_add_u32 s37, s37, 262144
P_k2:
    v_mfma_f32_32x32x16_bf16 v[178:193], v[34:37], v[130:133], 0
    v_mfma_f32_32x32x16_bf16 v[194:209], v[34:37], v[146:149], 0
    v_mfma_f32_32x32x16_bf16 v[178:193], v[38:41], v[134:137], v[178:193]
    v_mfma_f32_32x32x16_bf16 v[194:209], v[38:41], v[150:153], v[194:209]
    v_mfma_f32_32x32x16_bf16 v[178:193], v[42:45], v[138:141], v[178:193]
    v_mfma_f32_32x32x16_bf16 v[194:209], v[42:45], v[154:157], v[194:209]
    v_mfma_f32_32x32x16_bf16 v[178:193], v[46:49], v[142:145], v[178:193]
    v_mfma_f32_32x32x16_bf16 v[194:209], v[46:49], v[158:161], v[194:209]
    s_nop 11
    v_cvt_pk_bf16_f32 v178, v178, v194
    v_cvt_pk_bf16_f32 v179, v179, v195
    s_mov_b32 m0, s30
    s_nop 0
    ds_write_addtid_b32 v178 offset:57472
    v_cvt_pk_bf16_f32 v180, v180, v196
    ds_write_addtid_b32 v179 offset:57728
    v_cvt_pk_bf16_f32 v181, v181, v197
    ds_write_addtid_b32 v180 offset:57984
    v_cvt_pk_bf16_f32 v182, v182, v198
    ds_write_addtid_b32 v181 offset:58240
    v_cvt_pk_bf16_f32 v183, v183, v199
    ds_write_addtid_b32 v182 offset:58496
    v_cvt_pk_bf16_f32 v184, v184, v200
    ds_write_addtid_b32 v183 offset:58752
    v_cvt_pk_bf16_f32 v185, v185, v201
    ds_write_addtid_b32 v184 offset:59008
    v_cvt_pk_bf16_f32 v186, v186, v202
    ds_write_addtid_b32 v185 offset:59264
    v_cvt_pk_bf16_f32 v187, v187, v203
    ds_write_addtid_b32 v186 offset:59520
    v_cvt_pk_bf16_f32 v188, v188, v204
    ds_write_addtid_b32 v187 offset:59776
    v_cvt_pk_bf16_f32 v189, v189, v205
    ds_write_addtid_b32 v188 offset:60032
    v_cvt_pk_bf16_f32 v190, v190, v206
    ds_write_addtid_b32 v189 offset:60288
    v_cvt_pk_bf16_f32 v191, v191, v207
    ds_write_addtid_b32 v190 offset:60544
    v_cvt_pk_bf16_f32 v192, v192, v208
    ds_write_addtid_b32 v191 offset:60800
    v_cvt_pk_bf16_f32 v193, v193, v209
    ds_write_addtid_b32 v192 offset:61056
    ds_write_addtid_b32 v193 offset:61312
    s_waitcnt vmcnt(0)
    s_cmp_ge_u32 s35, 800
    s_cbranch_scc1 P_k4
    s_cmp_lg_u32 s22, 1
    s_cbranch_scc1 P_k3
    v_mov_b32 v238, s64
    v_mov_b32 v239, s65
    v_mov_b32 v240, s64
    v_mov_b32 v241, s65
    s_mov_b64 exec, 0xff
    buffer_store_dwordx4 v[238:241], v1, s[12:15], s38 offen sc1
    s_mov_b64 exec, -1
    s_branch P_k4
P_k3:
    v_mov_b32 v240, 0
    v_mov_b32 v238, s64
    v_mov_b32 v239, s65
    s_mov_b64 exec, 1
    buffer_store_dwordx2 v[238:239], v240, s[12:15], s38 offen sc1
    s_mov_b64 exec, -1
P_k4:
    s_mov_b32 s35, 4096
    s_mov_b32 s20, 0
    s_waitcnt vmcnt(1)
Q_4:
    v_cmp_ne_u64 vcc, s[64:65], v[234:235]
    s_cbranch_vccz Q_4ok
    s_sleep 1
    buffer_load_dwordx2 v[234:235], v246, s[12:15], s68 offen sc1
    s_add_u32 s20, s20, 1
    s_waitcnt vmcnt(0)
    s_cmp_lt_u32 s20, 0x8000
    s_cbranch_scc1 Q_4
Q_4ok:
    s_mov_b32 s20, 0
    s_waitcnt vmcnt(1)
Q_5:
    v_cmp_ne_u64 vcc, s[64:65], v[236:237]
    s_cbranch_vccz Q_5ok
    s_sleep 1
    buffer_load_dwordx2 v[236:237], v246, s[12:15], s31 offen sc1
    s_add_u32 s20, s20, 1
    s_waitcnt vmcnt(0)
    s_cmp_lt_u32 s20, 0x8000
    s_cbranch_scc1 Q_5
Q_5ok:
    buffer_load_dwordx4 v[234:237], v1, s[12:15], s28 offen offset:0 sc1
    buffer_load_dwordx4 v[238:241], v1, s[12:15], s28 offen offset:1024 sc1
    buffer_load_dwordx4 v[242:245], v1, s[12:15], s28 offen offset:2048 sc1
    buffer_load_dwordx4 v[246:249], v1, s[12:15], s28 offen offset:3072 sc1
    s_add_u32 s28, s28, 4096
    s_cmp_lg_u32 s22, 7
    s_cbranch_scc1 P_f
    s_mov_b32 s4, s40
    s_and_b32 s5, s41, 0xffff
    s_mov_b32 s6, 425984
    s_mov_b32 s7, 0x00020000
    s_mov_b32 m0, 156672
    s_mul_i32 s20, s34, 1664
    buffer_load_dwordx4 v1, s[4:7], s20 offen lds
    buffer_load_dwordx4 v1, s[4:7], s20 offen offset:1024 lds
    s_mov_b32 s4, s44
    s_and_b32 s5, s45, 0xffff
    s_mov_b32 s6, 2
    s_mov_b32 s7, 0x00020000
    s_mov_b32 m0, 158720
    v_mov_b32 v255, 0
    buffer_load_ushort v255, s[4:7], 0 offen lds
    s_mov_b32 s4, s52
    s_and_b32 s5, s53, 0xffff
    s_mov_b32 s6, 2
    s_mov_b32 s7, 0x00020000
    s_mov_b32 m0, 158976
    s_nop 0
    buffer_load_ushort v255, s[4:7], 0 offen lds
    s_mov_b32 s4, s42
    s_and_b32 s5, s43, 0xffff
    s_mov_b32 s6, 26
    s_mov_b32 s7, 0x00020000
    s_mov_b32 m0, 159232
    v_lshlrev_b32 v255, 1, v0
    buffer_load_ushort v255, s[4:7], 0 offen lds
    s_mov_b32 m0, s30
P_f:
    v_mfma_f32_32x32x16_bf16 v[178:193], v[50:53], v[130:133], 0
    v_mfma_f32_32x32x16_bf16 v[194:209], v[50:53], v[146:149], 0
    v_mfma_f32_32x32x16_bf16 v[178:193], v[54:57], v[134:137], v[178:193]
    v_mfma_f32_32x32x16_bf16 v[194:209], v[54:57], v[150:153], v[194:209]
    v_mfma_f32_32x32x16_bf16 v[178:193], v[58:61], v[138:141], v[178:193]
    v_mfma_f32_32x32x16_bf16 v[194:209], v[58:61], v[154:157], v[194:209]
    v_mfma_f32_32x32x16_bf16 v[178:193], v[62:65], v[142:145], v[178:193]
    v_mfma_f32_32x32x16_bf16 v[194:209], v[62:65], v[158:161], v[194:209]
    s_nop 11
    v_cvt_pk_bf16_f32 v178, v178, v194
    v_cvt_pk_bf16_f32 v179, v179, v195
    ds_write_addtid_b32 v178 offset:61568
    v_cvt_pk_bf16_f32 v180, v180, v196
    ds_write_addtid_b32 v179 offset:61824
    v_cvt_pk_bf16_f32 v181, v181, v197
    ds_write_addtid_b32 v180 offset:62080
    v_cvt_pk_bf16_f32 v182, v182, v198
    ds_write_addtid_b32 v181 offset:62336
    v_cvt_pk_bf16_f32 v183, v183, v199
    ds_write_addtid_b32 v182 offset:62592
    v_cvt_pk_bf16_f32 v184, v184, v200
    ds_write_addtid_b32 v183 offset:62848
    v_cvt_pk_bf16_f32 v185, v185, v201
    ds_write_addtid_b32 v184 offset:63104
    v_cvt_pk_bf16_f32 v186, v186, v202
    ds_write_addtid_b32 v185 offset:63360
    v_cvt_pk_bf16_f32 v187, v187, v203
    ds_write_addtid_b32 v186 offset:63616
    v_cvt_pk_bf16_f32 v188, v188, v204
    ds_write_addtid_b32 v187 offset:63872
    v_cvt_pk_bf16_f32 v189, v189, v205
    ds_write_addtid_b32 v188 offset:64128
    v_cvt_pk_bf16_f32 v190, v190, v206
    ds_write_addtid_b32 v189 offset:64384
    v_cvt_pk_bf16_f32 v191, v191, v207
    ds_write_addtid_b32 v190 offset:64640
    v_cvt_pk_bf16_f32 v192, v192, v208
    ds_write_addtid_b32 v191 offset:64896
    v_cvt_pk_bf16_f32 v193, v193, v209
    ds_write_addtid_b32 v192 offset:65152
    ds_write_addtid_b32 v193 offset:65408
    s_cmp_lt_u32 s35, 800
    s_cbranch_scc1 P_m7
    s_cmp_eq_u32 s22, 7
    s_cbranch_scc1 P_m7
    s_waitcnt vmcnt(3)
P_m7:
    s_waitcnt vmcnt(7)
    v_lshlrev_b32_sdwa v218, 3, v234 dst_sel:DWORD dst_unused:UNUSED_PAD src0_sel:DWORD src1_sel:WORD_0
    v_lshlrev_b32_sdwa v220, 3, v234 dst_sel:DWORD dst_unused:UNUSED_PAD src0_sel:DWORD src1_sel:WORD_1
    v_lshlrev_b32_sdwa v222, 3, v235 dst_sel:DWORD dst_unused:UNUSED_PAD src0_sel:DWORD src1_sel:WORD_0
    v_lshlrev_b32_sdwa v224, 3, v235 dst_sel:DWORD dst_unused:UNUSED_PAD src0_sel:DWORD src1_sel:WORD_1
    v_lshlrev_b32_sdwa v226, 3, v236 dst_sel:DWORD dst_unused:UNUSED_PAD src0_sel:DWORD src1_sel:WORD_0
    v_lshlrev_b32_sdwa v228, 3, v236 dst_sel:DWORD dst_unused:UNUSED_PAD src0_sel:DWORD src1_sel:WORD_1
    v_lshlrev_b32_sdwa v230, 3, v237 dst_sel:DWORD dst_unused:UNUSED_PAD src0_sel:DWORD src1_sel:WORD_0
    v_lshlrev_b32_sdwa v232, 3, v237 dst_sel:DWORD dst_unused:UNUSED_PAD src0_sel:DWORD src1_sel:WORD_1
    buffer_load_dwordx4 v[234:237], v1, s[12:15], s28 offen sc1
    s_setprio 3
    s_waitcnt lgkmcnt(0)
    s_barrier
    s_cmp_lt_u32 s35, 800
    s_cbranch_scc1 L_first
L_G1:
    ds_read_b64 v[218:219], v218
    ds_read_b64 v[220:221], v220
    ds_read_b64 v[222:223], v222
    ds_read_b64 v[224:225], v224
    ds_read_b64 v[226:227], v226
    ds_read_b64 v[228:229], v228
    ds_read_b64 v[230:231], v230
    ds_read_b64 v[232:233], v232
    s_waitcnt lgkmcnt(4)
    v_smfmac_f32_16x16x64_bf16 v[66:69], v[250:253], v[218:225], v254
    s_waitcnt vmcnt(3)
    v_lshlrev_b32_sdwa v218, 3, v238 dst_sel:DWORD dst_unused:UNUSED_PAD src0_sel:DWORD src1_sel:WORD_0
    v_lshlrev_b32_sdwa v220, 3, v238 dst_sel:DWORD dst_unused:UNUSED_PAD src0_sel:DWORD src1_sel:WORD_1
    v_lshlrev_b32_sdwa v222, 3, v239 dst_sel:DWORD dst_unused:UNUSED_PAD src0_sel:DWORD src1_sel:WORD_0
    v_lshlrev_b32_sdwa v224, 3, v239 dst_sel:DWORD dst_unused:UNUSED_PAD src0_sel:DWORD src1_sel:WORD_1
    ds_read_b64 v[218:219], v218
    ds_read_b64 v[220:221], v220
    ds_read_b64 v[222:223], v222
    ds_read_b64 v[224:225], v224
    s_waitcnt lgkmcnt(4)
    v_smfmac_f32_16x16x64_bf16 v[66:69], v[250:253], v[226:233], v254
    v_lshlrev_b32_sdwa v226, 3, v240 dst_sel:DWORD dst_unused:UNUSED_PAD src0_sel:DWORD src1_sel:WORD_0
    v_lshlrev_b32_sdwa v228, 3, v240 dst_sel:DWORD dst_unused:UNUSED_PAD src0_sel:DWORD src1_sel:WORD_1
    v_lshlrev_b32_sdwa v230, 3, v241 dst_sel:DWORD dst_unused:UNUSED_PAD src0_sel:DWORD src1_sel:WORD_0
    v_lshlrev_b32_sdwa v232, 3, v241 dst_sel:DWORD dst_unused:UNUSED_PAD src0_sel:DWORD src1_sel:WORD_1
    ds_read_b64 v[226:227], v226
    ds_read_b64 v[228:229], v228
    ds_read_b64 v[230:231], v230
    ds_read_b64 v[232:233], v232
    buffer_load_dwordx4 v[238:241], v1, s[12:15], s28 offen offset:1024 sc1
    s_waitcnt lgkmcnt(4)
    v_smfmac_f32_16x16x64_bf16 v[66:69], v[250:253], v[218:225], v254
    s_waitcnt vmcnt(3)
    v_lshlrev_b32_sdwa v218, 3, v242 dst_sel:DWORD dst_unused:UNUSED_PAD src0_sel:DWORD src1_sel:WORD_0
    v_lshlrev_b32_sdwa v220, 3, v242 dst_sel:DWORD dst_unused:UNUSED_PAD src0_sel:DWORD src1_sel:WORD_1
    v_lshlrev_b32_sdwa v222, 3, v243 dst_sel:DWORD dst_unused:UNUSED_PAD src0_sel:DWORD src1_sel:WORD_0
    v_lshlrev_b32_sdwa v224, 3, v243 dst_sel:DWORD dst_unused:UNUSED_PAD src0_sel:DWORD src1_sel:WORD_1
    ds_read_b64 v[218:219], v218
    ds_read_b64 v[220:221], v220
    ds_read_b64 v[222:223], v222
    ds_read_b64 v[224:225], v224
    s_waitcnt lgkmcnt(4)
    v_smfmac_f32_16x16x64_bf16 v[66:69], v[250:253], v[226:233], v254
    v_lshlrev_b32_sdwa v226, 3, v244 dst_sel:DWORD dst_unused:UNUSED_PAD src0_sel:DWORD src1_sel:WORD_0
    v_lshlrev_b32_sdwa v228, 3, v244 dst_sel:DWORD dst_unused:UNUSED_PAD src0_sel:DWORD src1_sel:WORD_1
    v_lshlrev_b32_sdwa v230, 3, v245 dst_sel:DWORD dst_unused:UNUSED_PAD src0_sel:DWORD src1_sel:WORD_0
    v_lshlrev_b32_sdwa v232, 3, v245 dst_sel:DWORD dst_unused:UNUSED_PAD src0_sel:DWORD src1_sel:WORD_1
    ds_read_b64 v[226:227], v226
    ds_read_b64 v[228:229], v228
    ds_read_b64 v[230:231], v230
    ds_read_b64 v[232:233], v232
    buffer_load_dwordx4 v[242:245], v1, s[12:15], s28 offen offset:2048 sc1
    s_setprio 2
    s_waitcnt lgkmcnt(4)
    v_smfmac_f32_16x16x64_bf16 v[70:73], v[250:253], v[218:225], v254
    s_waitcnt vmcnt(3)
    v_lshlrev_b32_sdwa v218, 3, v246 dst_sel:DWORD dst_unused:UNUSED_PAD src0_sel:DWORD src1_sel:WORD_0
    v_lshlrev_b32_sdwa v220, 3, v246 dst_sel:DWORD dst_unused:UNUSED_PAD src0_sel:DWORD src1_sel:WORD_1
    v_lshlrev_b32_sdwa v222, 3, v247 dst_sel:DWORD dst_unused:UNUSED_PAD src0_sel:DWORD src1_sel:WORD_0
    v_lshlrev_b32_sdwa v224, 3, v247 dst_sel:DWORD dst_unused:UNUSED_PAD src0_sel:DWORD src1_sel:WORD_1
    ds_read_b64 v[218:219], v218
    ds_read_b64 v[220:221], v220
    ds_read_b64 v[222:223], v222
    ds_read_b64 v[224:225], v224
    s_waitcnt lgkmcnt(4)
    v_smfmac_f32_16x16x64_bf16 v[70:73], v[250:253], v[226:233], v254
    v_lshlrev_b32_sdwa v226, 3, v248 dst_sel:DWORD dst_unused:UNUSED_PAD src0_sel:DWORD src1_sel:WORD_0
    v_lshlrev_b32_sdwa v228, 3, v248 dst_sel:DWORD dst_unused:UNUSED_PAD src0_sel:DWORD src1_sel:WORD_1
    v_lshlrev_b32_sdwa v230, 3, v249 dst_sel:DWORD dst_unused:UNUSED_PAD src0_sel:DWORD src1_sel:WORD_0
    v_lshlrev_b32_sdwa v232, 3, v249 dst_sel:DWORD dst_unused:UNUSED_PAD src0_sel:DWORD src1_sel:WORD_1
    ds_read_b64 v[226:227], v226
    ds_read_b64 v[228:229], v228
    ds_read_b64 v[230:231], v230
    ds_read_b64 v[232:233], v232
    buffer_load_dwordx4 v[246:249], v1, s[12:15], s28 offen offset:3072 sc1
    s_add_u32 s28, s28, 4096
    s_waitcnt lgkmcnt(4)
    v_smfmac_f32_16x16x64_bf16 v[70:73], v[250:253], v[218:225], v254
    s_waitcnt vmcnt(3)
    v_lshlrev_b32_sdwa v218, 3, v234 dst_sel:DWORD dst_unused:UNUSED_PAD src0_sel:DWORD src1_sel:WORD_0
    v_lshlrev_b32_sdwa v220, 3, v234 dst_sel:DWORD dst_unused:UNUSED_PAD src0_sel:DWORD src1_sel:WORD_1
    v_lshlrev_b32_sdwa v222, 3, v235 dst_sel:DWORD dst_unused:UNUSED_PAD src0_sel:DWORD src1_sel:WORD_0
    v_lshlrev_b32_sdwa v224, 3, v235 dst_sel:DWORD dst_unused:UNUSED_PAD src0_sel:DWORD src1_sel:WORD_1
    ds_read_b64 v[218:219], v218
    ds_read_b64 v[220:221], v220
    ds_read_b64 v[222:223], v222
    ds_read_b64 v[224:225], v224
    v_min_u32 v164, 7, v0
    v_lshlrev_b32 v164, 7, v164
    buffer_load_dwordx2 v[162:163], v164, s[12:15], s39 offen sc1
    s_waitcnt lgkmcnt(4)
    v_smfmac_f32_16x16x64_bf16 v[70:73], v[250:253], v[226:233], v254
    v_lshlrev_b32_sdwa v226, 3, v236 dst_sel:DWORD dst_unused:UNUSED_PAD src0_sel:DWORD src1_sel:WORD_0
    v_lshlrev_b32_sdwa v228, 3, v236 dst_sel:DWORD dst_unused:UNUSED_PAD src0_sel:DWORD src1_sel:WORD_1
    v_lshlrev_b32_sdwa v230, 3, v237 dst_sel:DWORD dst_unused:UNUSED_PAD src0_sel:DWORD src1_sel:WORD_0
    v_lshlrev_b32_sdwa v232, 3, v237 dst_sel:DWORD dst_unused:UNUSED_PAD src0_sel:DWORD src1_sel:WORD_1
    ds_read_b64 v[226:227], v226
    ds_read_b64 v[228:229], v228
    ds_read_b64 v[230:231], v230
    ds_read_b64 v[232:233], v232
    buffer_load_dwordx4 v[234:237], v1, s[12:15], s28 offen offset:0 sc1
    s_waitcnt lgkmcnt(4)
    v_smfmac_f32_16x16x64_bf16 v[74:77], v[250:253], v[218:225], v254
    s_waitcnt vmcnt(4)
    v_lshlrev_b32_sdwa v218, 3, v238 dst_sel:DWORD dst_unused:UNUSED_PAD src0_sel:DWORD src1_sel:WORD_0
    v_lshlrev_b32_sdwa v220, 3, v238 dst_sel:DWORD dst_unused:UNUSED_PAD src0_sel:DWORD src1_sel:WORD_1
    v_lshlrev_b32_sdwa v222, 3, v239 dst_sel:DWORD dst_unused:UNUSED_PAD src0_sel:DWORD src1_sel:WORD_0
    v_lshlrev_b32_sdwa v224, 3, v239 dst_sel:DWORD dst_unused:UNUSED_PAD src0_sel:DWORD src1_sel:WORD_1
    ds_read_b64 v[218:219], v218
    ds_read_b64 v[220:221], v220
    ds_read_b64 v[222:223], v222
    ds_read_b64 v[224:225], v224
    s_setprio 1
    s_waitcnt lgkmcnt(4)
    v_smfmac_f32_16x16x64_bf16 v[74:77], v[250:253], v[226:233], v254
    v_lshlrev_b32_sdwa v226, 3, v240 dst_sel:DWORD dst_unused:UNUSED_PAD src0_sel:DWORD src1_sel:WORD_0
    v_lshlrev_b32_sdwa v228, 3, v240 dst_sel:DWORD dst_unused:UNUSED_PAD src0_sel:DWORD src1_sel:WORD_1
    v_lshlrev_b32_sdwa v230, 3, v241 dst_sel:DWORD dst_unused:UNUSED_PAD src0_sel:DWORD src1_sel:WORD_0
    v_lshlrev_b32_sdwa v232, 3, v241 dst_sel:DWORD dst_unused:UNUSED_PAD src0_sel:DWORD src1_sel:WORD_1
    ds_read_b64 v[226:227], v226
    ds_read_b64 v[228:229], v228
    ds_read_b64 v[230:231], v230
    ds_read_b64 v[232:233], v232
    buffer_load_dwordx4 v[238:241], v1, s[12:15], s28 offen offset:1024 sc1
    s_waitcnt lgkmcnt(4)
    v_smfmac_f32_16x16x64_bf16 v[74:77], v[250:253], v[218:225], v254
    s_waitcnt vmcnt(4)
    v_lshlrev_b32_sdwa v218, 3, v242 dst_sel:DWORD dst_unused:UNUSED_PAD src0_sel:DWORD src1_sel:WORD_0
    v_lshlrev_b32_sdwa v220, 3, v242 dst_sel:DWORD dst_unused:UNUSED_PAD src0_sel:DWORD src1_sel:WORD_1
    v_lshlrev_b32_sdwa v222, 3, v243 dst_sel:DWORD dst_unused:UNUSED_PAD src0_sel:DWORD src1_sel:WORD_0
    v_lshlrev_b32_sdwa v224, 3, v243 dst_sel:DWORD dst_unused:UNUSED_PAD src0_sel:DWORD src1_sel:WORD_1
    ds_read_b64 v[218:219], v218
    ds_read_b64 v[220:221], v220
    ds_read_b64 v[222:223], v222
    ds_read_b64 v[224:225], v224
    s_waitcnt vmcnt(2)
    v_cmp_ne_u64 vcc, s[64:65], v[162:163]
    s_cbranch_vccnz W_slow
W_back:
    buffer_load_dwordx4 v[162:165], v1, s[12:15], s26 offen sc1
    s_add_u32 s26, s26, 16384
    s_waitcnt lgkmcnt(4)
    v_smfmac_f32_16x16x64_bf16 v[74:77], v[250:253], v[226:233], v254
    v_lshlrev_b32_sdwa v226, 3, v244 dst_sel:DWORD dst_unused:UNUSED_PAD src0_sel:DWORD src1_sel:WORD_0
    v_lshlrev_b32_sdwa v228, 3, v244 dst_sel:DWORD dst_unused:UNUSED_PAD src0_sel:DWORD src1_sel:WORD_1
    v_lshlrev_b32_sdwa v230, 3, v245 dst_sel:DWORD dst_unused:UNUSED_PAD src0_sel:DWORD src1_sel:WORD_0
    v_lshlrev_b32_sdwa v232, 3, v245 dst_sel:DWORD dst_unused:UNUSED_PAD src0_sel:DWORD src1_sel:WORD_1
    ds_read_b64 v[226:227], v226
    ds_read_b64 v[228:229], v228
    ds_read_b64 v[230:231], v230
    ds_read_b64 v[232:233], v232
    buffer_load_dwordx4 v[242:245], v1, s[12:15], s28 offen offset:2048 sc1
    s_waitcnt lgkmcnt(4)
    v_smfmac_f32_16x16x64_bf16 v[78:81], v[250:253], v[218:225], v254
    s_waitcnt vmcnt(5)
    v_lshlrev_b32_sdwa v218, 3, v246 dst_sel:DWORD dst_unused:UNUSED_PAD src0_sel:DWORD src1_sel:WORD_0
    v_lshlrev_b32_sdwa v220, 3, v246 dst_sel:DWORD dst_unused:UNUSED_PAD src0_sel:DWORD src1_sel:WORD_1
    v_lshlrev_b32_sdwa v222, 3, v247 dst_sel:DWORD dst_unused:UNUSED_PAD src0_sel:DWORD src1_sel:WORD_0
    v_lshlrev_b32_sdwa v224, 3, v247 dst_sel:DWORD dst_unused:UNUSED_PAD src0_sel:DWORD src1_sel:WORD_1
    ds_read_b64 v[218:219], v218
    ds_read_b64 v[220:221], v220
    ds_read_b64 v[222:223], v222
    ds_read_b64 v[224:225], v224
    s_setprio 0
    s_waitcnt lgkmcnt(4)
    v_smfmac_f32_16x16x64_bf16 v[78:81], v[250:253], v[226:233], v254
    v_lshlrev_b32_sdwa v226, 3, v248 dst_sel:DWORD dst_unused:UNUSED_PAD src0_sel:DWORD src1_sel:WORD_0
    v_lshlrev_b32_sdwa v228, 3, v248 dst_sel:DWORD dst_unused:UNUSED_PAD src0_sel:DWORD src1_sel:WORD_1
    v_lshlrev_b32_sdwa v230, 3, v249 dst_sel:DWORD dst_unused:UNUSED_PAD src0_sel:DWORD src1_sel:WORD_0
    v_lshlrev_b32_sdwa v232, 3, v249 dst_sel:DWORD dst_unused:UNUSED_PAD src0_sel:DWORD src1_sel:WORD_1
    ds_read_b64 v[226:227], v226
    ds_read_b64 v[228:229], v228
    ds_read_b64 v[230:231], v230
    ds_read_b64 v[232:233], v232
    buffer_load_dwordx4 v[246:249], v1, s[12:15], s28 offen offset:3072 sc1
    s_add_u32 s28, s28, 4096
    s_waitcnt lgkmcnt(4)
    v_smfmac_f32_16x16x64_bf16 v[78:81], v[250:253], v[218:225], v254
    s_waitcnt vmcnt(4)
    v_lshlrev_b32_sdwa v218, 3, v234 dst_sel:DWORD dst_unused:UNUSED_PAD src0_sel:DWORD src1_sel:WORD_0
    v_lshlrev_b32_sdwa v220, 3, v234 dst_sel:DWORD dst_unused:UNUSED_PAD src0_sel:DWORD src1_sel:WORD_1
    v_lshlrev_b32_sdwa v222, 3, v235 dst_sel:DWORD dst_unused:UNUSED_PAD src0_sel:DWORD src1_sel:WORD_0
    v_lshlrev_b32_sdwa v224, 3, v235 dst_sel:DWORD dst_unused:UNUSED_PAD src0_sel:DWORD src1_sel:WORD_1
    ds_read_b64 v[218:219], v218
    ds_read_b64 v[220:221], v220
    ds_read_b64 v[222:223], v222
    ds_read_b64 v[224:225], v224
    s_waitcnt lgkmcnt(4)
    v_smfmac_f32_16x16x64_bf16 v[78:81], v[250:253], v[226:233], v254
    v_lshlrev_b32_sdwa v226, 3, v236 dst_sel:DWORD dst_unused:UNUSED_PAD src0_sel:DWORD src1_sel:WORD_0
    v_lshlrev_b32_sdwa v228, 3, v236 dst_sel:DWORD dst_unused:UNUSED_PAD src0_sel:DWORD src1_sel:WORD_1
    v_lshlrev_b32_sdwa v230, 3, v237 dst_sel:DWORD dst_unused:UNUSED_PAD src0_sel:DWORD src1_sel:WORD_0
    v_lshlrev_b32_sdwa v232, 3, v237 dst_sel:DWORD dst_unused:UNUSED_PAD src0_sel:DWORD src1_sel:WORD_1
    ds_read_b64 v[226:227], v226
    ds_read_b64 v[228:229], v228
    ds_read_b64 v[230:231], v230
    ds_read_b64 v[232:233], v232
    buffer_load_dwordx4 v[234:237], v1, s[12:15], s28 offen offset:0 sc1
    s_waitcnt lgkmcnt(4)
    v_smfmac_f32_16x16x64_bf16 v[82:85], v[250:253], v[218:225], v254
    s_waitcnt vmcnt(4)
    v_lshlrev_b32_sdwa v218, 3, v238 dst_sel:DWORD dst_unused:UNUSED_PAD src0_sel:DWORD src1_sel:WORD_0
    v_lshlrev_b32_sdwa v220, 3, v238 dst_sel:DWORD dst_unused:UNUSED_PAD src0_sel:DWORD src1_sel:WORD_1
    v_lshlrev_b32_sdwa v222, 3, v239 dst_sel:DWORD dst_unused:UNUSED_PAD src0_sel:DWORD src1_sel:WORD_0
    v_lshlrev_b32_sdwa v224, 3, v239 dst_sel:DWORD dst_unused:UNUSED_PAD src0_sel:DWORD src1_sel:WORD_1
    ds_read_b64 v[218:219], v218
    ds_read_b64 v[220:221], v220
    ds_read_b64 v[222:223], v222
    ds_read_b64 v[224:225], v224
    s_waitcnt lgkmcnt(4)
    v_smfmac_f32_16x16x64_bf16 v[82:85], v[250:253], v[226:233], v254
    v_lshlrev_b32_sdwa v226, 3, v240 dst_sel:DWORD dst_unused:UNUSED_PAD src0_sel:DWORD src1_sel:WORD_0
    v_lshlrev_b32_sdwa v228, 3, v240 dst_sel:DWORD dst_unused:UNUSED_PAD src0_sel:DWORD src1_sel:WORD_1
    v_lshlrev_b32_sdwa v230, 3, v241 dst_sel:DWORD dst_unused:UNUSED_PAD src0_sel:DWORD src1_sel:WORD_0
    v_lshlrev_b32_sdwa v232, 3, v241 dst_sel:DWORD dst_unused:UNUSED_PAD src0_sel:DWORD src1_sel:WORD_1
    ds_read_b64 v[226:227], v226
    ds_read_b64 v[228:229], v228
    ds_read_b64 v[230:231], v230
    ds_read_b64 v[232:233], v232
    buffer_load_dwordx4 v[238:241], v1, s[12:15], s28 offen offset:1024 sc1
    v_add_u32 v166, s33, v1
    s_waitcnt vmcnt(4)
    ds_write_b128 v166, v[162:165]
    v_mov_b32 v168, 163836
    v_mov_b32 v169, 1
    s_mov_b64 exec, 1
    ds_add_u32 v168, v169
    s_mov_b64 exec, -1
    s_setprio 3
    s_waitcnt lgkmcnt(4)
    v_smfmac_f32_16x16x64_bf16 v[82:85], v[250:253], v[218:225], v254
    s_waitcnt vmcnt(3)
    v_lshlrev_b32_sdwa v218, 3, v242 dst_sel:DWORD dst_unused:UNUSED_PAD src0_sel:DWORD src1_sel:WORD_0
    v_lshlrev_b32_sdwa v220, 3, v242 dst_sel:DWORD dst_unused:UNUSED_PAD src0_sel:DWORD src1_sel:WORD_1
    v_lshlrev_b32_sdwa v222, 3, v243 dst_sel:DWORD dst_unused:UNUSED_PAD src0_sel:DWORD src1_sel:WORD_0
    v_lshlrev_b32_sdwa v224, 3, v243 dst_sel:DWORD dst_unused:UNUSED_PAD src0_sel:DWORD src1_sel:WORD_1
    ds_read_b64 v[218:219], v218
    ds_read_b64 v[220:221], v220
    ds_read_b64 v[222:223], v222
    ds_read_b64 v[224:225], v224
    ds_read_b32 v169, v168
    s_waitcnt lgkmcnt(4)
    v_smfmac_f32_16x16x64_bf16 v[82:85], v[250:253], v[226:233], v254
    v_lshlrev_b32_sdwa v226, 3, v244 dst_sel:DWORD dst_unused:UNUSED_PAD src0_sel:DWORD src1_sel:WORD_0
    v_lshlrev_b32_sdwa v228, 3, v244 dst_sel:DWORD dst_unused:UNUSED_PAD src0_sel:DWORD src1_sel:WORD_1
    v_lshlrev_b32_sdwa v230, 3, v245 dst_sel:DWORD dst_unused:UNUSED_PAD src0_sel:DWORD src1_sel:WORD_0
    v_lshlrev_b32_sdwa v232, 3, v245 dst_sel:DWORD dst_unused:UNUSED_PAD src0_sel:DWORD src1_sel:WORD_1
    ds_read_b64 v[226:227], v226
    ds_read_b64 v[228:229], v228
    ds_read_b64 v[230:231], v230
    ds_read_b64 v[232:233], v232
    buffer_load_dwordx4 v[242:245], v1, s[12:15], s28 offen offset:2048 sc1
    s_waitcnt lgkmcnt(4)
    v_smfmac_f32_16x16x64_bf16 v[86:89], v[250:253], v[218:225], v254
    s_waitcnt vmcnt(3)
    v_lshlrev_b32_sdwa v218, 3, v246 dst_sel:DWORD dst_unused:UNUSED_PAD src0_sel:DWORD src1_sel:WORD_0
    v_lshlrev_b32_sdwa v220, 3, v246 dst_sel:DWORD dst_unused:UNUSED_PAD src0_sel:DWORD src1_sel:WORD_1
    v_lshlrev_b32_sdwa v222, 3, v247 dst_sel:DWORD dst_unused:UNUSED_PAD src0_sel:DWORD src1_sel:WORD_0
    v_lshlrev_b32_sdwa v224, 3, v247 dst_sel:DWORD dst_unused:UNUSED_PAD src0_sel:DWORD src1_sel:WORD_1
    ds_read_b64 v[218:219], v218
    ds_read_b64 v[220:221], v220
    ds_read_b64 v[222:223], v222
    ds_read_b64 v[224:225], v224
    v_add_u32 v166, 131072, v1
    v_readfirstlane_b32 s20, v169
    s_cmp_lt_u32 s20, 8
    s_cbranch_scc1 J_slow
J_back:
    ds_read_b128 v[130:133], v166 offset:0
    ds_read_b128 v[146:149], v166 offset:12800
    ds_read_b128 v[134:137], v166 offset:3200
    ds_read_b128 v[150:153], v166 offset:16000
    ds_read_b128 v[138:141], v166 offset:6400
    ds_read_b128 v[154:157], v166 offset:19200
    ds_read_b128 v[142:145], v166 offset:9600
    ds_read_b128 v[158:161], v166 offset:22400
    s_waitcnt lgkmcnt(4)
    v_smfmac_f32_16x16x64_bf16 v[86:89], v[250:253], v[226:233], v254
    v_lshlrev_b32_sdwa v226, 3, v248 dst_sel:DWORD dst_unused:UNUSED_PAD src0_sel:DWORD src1_sel:WORD_0
    v_lshlrev_b32_sdwa v228, 3, v248 dst_sel:DWORD dst_unused:UNUSED_PAD src0_sel:DWORD src1_sel:WORD_1
    v_lshlrev_b32_sdwa v230, 3, v249 dst_sel:DWORD dst_unused:UNUSED_PAD src0_sel:DWORD src1_sel:WORD_0
    v_lshlrev_b32_sdwa v232, 3, v249 dst_sel:DWORD dst_unused:UNUSED_PAD src0_sel:DWORD src1_sel:WORD_1
    ds_read_b64 v[226:227], v226
    ds_read_b64 v[228:229], v228
    ds_read_b64 v[230:231], v230
    ds_read_b64 v[232:233], v232
    buffer_load_dwordx4 v[246:249], v1, s[12:15], s28 offen offset:3072 sc1
    s_add_u32 s28, s28, 4096
    s_add_u32 s28, s28, s46
    v_min_u32 v212, 17, v0
    v_lshlrev_b32 v212, 3, v212
    buffer_load_dwordx2 v[210:211], v212, s[12:15], s29 offen sc1
    s_waitcnt lgkmcnt(4)
    v_smfmac_f32_16x16x64_bf16 v[86:89], v[250:253], v[218:225], v254
    s_waitcnt vmcnt(4)
    v_lshlrev_b32_sdwa v218, 3, v234 dst_sel:DWORD dst_unused:UNUSED_PAD src0_sel:DWORD src1_sel:WORD_0
    v_lshlrev_b32_sdwa v220, 3, v234 dst_sel:DWORD dst_unused:UNUSED_PAD src0_sel:DWORD src1_sel:WORD_1
    v_lshlrev_b32_sdwa v222, 3, v235 dst_sel:DWORD dst_unused:UNUSED_PAD src0_sel:DWORD src1_sel:WORD_0
    v_lshlrev_b32_sdwa v224, 3, v235 dst_sel:DWORD dst_unused:UNUSED_PAD src0_sel:DWORD src1_sel:WORD_1
    ds_read_b64 v[218:219], v218
    ds_read_b64 v[220:221], v220
    ds_read_b64 v[222:223], v222
    ds_read_b64 v[224:225], v224
    s_waitcnt lgkmcnt(4)
    v_smfmac_f32_16x16x64_bf16 v[86:89], v[250:253], v[226:233], v254
    v_lshlrev_b32_sdwa v226, 3, v236 dst_sel:DWORD dst_unused:UNUSED_PAD src0_sel:DWORD src1_sel:WORD_0
    v_lshlrev_b32_sdwa v228, 3, v236 dst_sel:DWORD dst_unused:UNUSED_PAD src0_sel:DWORD src1_sel:WORD_1
    v_lshlrev_b32_sdwa v230, 3, v237 dst_sel:DWORD dst_unused:UNUSED_PAD src0_sel:DWORD src1_sel:WORD_0
    v_lshlrev_b32_sdwa v232, 3, v237 dst_sel:DWORD dst_unused:UNUSED_PAD src0_sel:DWORD src1_sel:WORD_1
    v_mfma_f32_32x32x16_bf16 v[178:193], v[2:5], v[130:133], 0
    v_mfma_f32_32x32x16_bf16 v[194:209], v[2:5], v[146:149], 0
    ds_read_b64 v[226:227], v226
    ds_read_b64 v[228:229], v228
    ds_read_b64 v[230:231], v230
    ds_read_b64 v[232:233], v232
    buffer_load_dwordx4 v[234:237], v1, s[12:15], s28 offen offset:0 sc1
    s_waitcnt lgkmcnt(4)
    v_smfmac_f32_16x16x64_bf16 v[90:93], v[250:253], v[218:225], v254
    s_waitcnt vmcnt(4)
    v_lshlrev_b32_sdwa v218, 3, v238 dst_sel:DWORD dst_unused:UNUSED_PAD src0_sel:DWORD src1_sel:WORD_0
    v_lshlrev_b32_sdwa v220, 3, v238 dst_sel:DWORD dst_unused:UNUSED_PAD src0_sel:DWORD src1_sel:WORD_1
    v_lshlrev_b32_sdwa v222, 3, v239 dst_sel:DWORD dst_unused:UNUSED_PAD src0_sel:DWORD src1_sel:WORD_0
    v_lshlrev_b32_sdwa v224, 3, v239 dst_sel:DWORD dst_unused:UNUSED_PAD src0_sel:DWORD src1_sel:WORD_1
    v_mfma_f32_32x32x16_bf16 v[178:193], v[6:9], v[134:137], v[178:193]
    v_mfma_f32_32x32x16_bf16 v[194:209], v[6:9], v[150:153], v[194:209]
    ds_read_b64 v[218:219], v218
    ds_read_b64 v[220:221], v220
    ds_read_b64 v[222:223], v222
    ds_read_b64 v[224:225], v224
    s_waitcnt lgkmcnt(4)
    v_smfmac_f32_16x16x64_bf16 v[90:93], v[250:253], v[226:233], v254
    v_lshlrev_b32_sdwa v226, 3, v240 dst_sel:DWORD dst_unused:UNUSED_PAD src0_sel:DWORD src1_sel:WORD_0
    v_lshlrev_b32_sdwa v228, 3, v240 dst_sel:DWORD dst_unused:UNUSED_PAD src0_sel:DWORD src1_sel:WORD_1
    v_lshlrev_b32_sdwa v230, 3, v241 dst_sel:DWORD dst_unused:UNUSED_PAD src0_sel:DWORD src1_sel:WORD_0
    v_lshlrev_b32_sdwa v232, 3, v241 dst_sel:DWORD dst_unused:UNUSED_PAD src0_sel:DWORD src1_sel:WORD_1
    v_mfma_f32_32x32x16_bf16 v[178:193], v[10:13], v[138:141], v[178:193]
    v_mfma_f32_32x32x16_bf16 v[194:209], v[10:13], v[154:157], v[194:209]
    ds_read_b64 v[226:227], v226
    ds_read_b64 v[228:229], v228
    ds_read_b64 v[230:231], v230
    ds_read_b64 v[232:233], v232
    buffer_load_dwordx4 v[238:241], v1, s[12:15], s28 offen offset:1024 sc1
    s_waitcnt lgkmcnt(4)
    v_smfmac_f32_16x16x64_bf16 v[90:93], v[250:253], v[218:225], v254
    s_waitcnt vmcnt(4)
    v_lshlrev_b32_sdwa v218, 3, v242 dst_sel:DWORD dst_unused:UNUSED_PAD src0_sel:DWORD src1_sel:WORD_0
    v_lshlrev_b32_sdwa v220, 3, v242 dst_sel:DWORD dst_unused:UNUSED_PAD src0_sel:DWORD src1_sel:WORD_1
    v_lshlrev_b32_sdwa v222, 3, v243 dst_sel:DWORD dst_unused:UNUSED_PAD src0_sel:DWORD src1_sel:WORD_0
    v_lshlrev_b32_sdwa v224, 3, v243 dst_sel:DWORD dst_unused:UNUSED_PAD src0_sel:DWORD src1_sel:WORD_1
    v_mfma_f32_32x32x16_bf16 v[178:193], v[14:17], v[142:145], v[178:193]
    v_mfma_f32_32x32x16_bf16 v[194:209], v[14:17], v[158:161], v[194:209]
    ds_read_b64 v[218:219], v218
    ds_read_b64 v[220:221], v220
    ds_read_b64 v[222:223], v222
    ds_read_b64 v[224:225], v224
    s_waitcnt lgkmcnt(4)
    v_smfmac_f32_16x16x64_bf16 v[90:93], v[250:253], v[226:233], v254
    v_lshlrev_b32_sdwa v226, 3, v244 dst_sel:DWORD dst_unused:UNUSED_PAD src0_sel:DWORD src1_sel:WORD_0
    v_lshlrev_b32_sdwa v228, 3, v244 dst_sel:DWORD dst_unused:UNUSED_PAD src0_sel:DWORD src1_sel:WORD_1
    v_lshlrev_b32_sdwa v230, 3, v245 dst_sel:DWORD dst_unused:UNUSED_PAD src0_sel:DWORD src1_sel:WORD_0
    v_lshlrev_b32_sdwa v232, 3, v245 dst_sel:DWORD dst_unused:UNUSED_PAD src0_sel:DWORD src1_sel:WORD_1
    ds_read_b64 v[226:227], v226
    ds_read_b64 v[228:229], v228
    ds_read_b64 v[230:231], v230
    ds_read_b64 v[232:233], v232
    buffer_load_dwordx4 v[242:245], v1, s[12:15], s28 offen offset:2048 sc1
    s_waitcnt lgkmcnt(4)
    v_smfmac_f32_16x16x64_bf16 v[94:97], v[250:253], v[218:225], v254
    s_waitcnt vmcnt(4)
    v_lshlrev_b32_sdwa v218, 3, v246 dst_sel:DWORD dst_unused:UNUSED_PAD src0_sel:DWORD src1_sel:WORD_0
    v_lshlrev_b32_sdwa v220, 3, v246 dst_sel:DWORD dst_unused:UNUSED_PAD src0_sel:DWORD src1_sel:WORD_1
    v_lshlrev_b32_sdwa v222, 3, v247 dst_sel:DWORD dst_unused:UNUSED_PAD src0_sel:DWORD src1_sel:WORD_0
    v_lshlrev_b32_sdwa v224, 3, v247 dst_sel:DWORD dst_unused:UNUSED_PAD src0_sel:DWORD src1_sel:WORD_1
    v_cvt_pk_bf16_f32 v162, v178, v194
    v_cvt_pk_bf16_f32 v163, v179, v195
    v_cvt_pk_bf16_f32 v164, v180, v196
    v_cvt_pk_bf16_f32 v165, v181, v197
    v_cvt_pk_bf16_f32 v166, v182, v198
    ds_read_b64 v[218:219], v218
    ds_read_b64 v[220:221], v220
    ds_read_b64 v[222:223], v222
    ds_read_b64 v[224:225], v224
    s_setprio 2
    s_waitcnt lgkmcnt(4)
    v_smfmac_f32_16x16x64_bf16 v[94:97], v[250:253], v[226:233], v254
    v_lshlrev_b32_sdwa v226, 3, v248 dst_sel:DWORD dst_unused:UNUSED_PAD src0_sel:DWORD src1_sel:WORD_0
    v_lshlrev_b32_sdwa v228, 3, v248 dst_sel:DWORD dst_unused:UNUSED_PAD src0_sel:DWORD src1_sel:WORD_1
    v_lshlrev_b32_sdwa v230, 3, v249 dst_sel:DWORD dst_unused:UNUSED_PAD src0_sel:DWORD src1_sel:WORD_0
    v_lshlrev_b32_sdwa v232, 3, v249 dst_sel:DWORD dst_unused:UNUSED_PAD src0_sel:DWORD src1_sel:WORD_1
    v_cvt_pk_bf16_f32 v167, v183, v199
    v_cvt_pk_bf16_f32 v168, v184, v200
    v_cvt_pk_bf16_f32 v169, v185, v201
    v_cvt_pk_bf16_f32 v170, v186, v202
    v_cvt_pk_bf16_f32 v171, v187, v203
    ds_read_b64 v[226:227], v226
    ds_read_b64 v[228:229], v228
    ds_read_b64 v[230:231], v230
    ds_read_b64 v[232:233], v232
    buffer_load_dwordx4 v[246:249], v1, s[12:15], s28 offen offset:3072 sc1
    s_add_u32 s28, s28, 4096
    s_waitcnt vmcnt(4)
    v_cmp_ne_u64 vcc, s[64:65], v[210:211]
    s_cbranch_vccnz Z_slow
Z_back:
    s_waitcnt lgkmcnt(4)
    v_smfmac_f32_16x16x64_bf16 v[94:97], v[250:253], v[218:225], v254
    s_waitcnt vmcnt(3)
    v_lshlrev_b32_sdwa v218, 3, v234 dst_sel:DWORD dst_unused:UNUSED_PAD src0_sel:DWORD src1_sel:WORD_0
    v_lshlrev_b32_sdwa v220, 3, v234 dst_sel:DWORD dst_unused:UNUSED_PAD src0_sel:DWORD src1_sel:WORD_1
    v_lshlrev_b32_sdwa v222, 3, v235 dst_sel:DWORD dst_unused:UNUSED_PAD src0_sel:DWORD src1_sel:WORD_0
    v_lshlrev_b32_sdwa v224, 3, v235 dst_sel:DWORD dst_unused:UNUSED_PAD src0_sel:DWORD src1_sel:WORD_1
    v_cvt_pk_bf16_f32 v172, v188, v204
    v_cvt_pk_bf16_f32 v173, v189, v205
    v_cvt_pk_bf16_f32 v174, v190, v206
    v_cvt_pk_bf16_f32 v175, v191, v207
    v_cvt_pk_bf16_f32 v176, v192, v208
    ds_read_b64 v[218:219], v218
    ds_read_b64 v[220:221], v220
    ds_read_b64 v[222:223], v222
    ds_read_b64 v[224:225], v224
    s_waitcnt lgkmcnt(4)
    v_smfmac_f32_16x16x64_bf16 v[94:97], v[250:253], v[226:233], v254
    v_lshlrev_b32_sdwa v226, 3, v236 dst_sel:DWORD dst_unused:UNUSED_PAD src0_sel:DWORD src1_sel:WORD_0
    v_lshlrev_b32_sdwa v228, 3, v236 dst_sel:DWORD dst_unused:UNUSED_PAD src0_sel:DWORD src1_sel:WORD_1
    v_lshlrev_b32_sdwa v230, 3, v237 dst_sel:DWORD dst_unused:UNUSED_PAD src0_sel:DWORD src1_sel:WORD_0
    v_lshlrev_b32_sdwa v232, 3, v237 dst_sel:DWORD dst_unused:UNUSED_PAD src0_sel:DWORD src1_sel:WORD_1
    v_cvt_pk_bf16_f32 v177, v193, v209
    v_mfma_f32_32x32x16_bf16 v[178:193], v[18:21], v[130:133], 0
    v_mfma_f32_32x32x16_bf16 v[194:209], v[18:21], v[146:149], 0
    ds_read_b64 v[226:227], v226
    ds_read_b64 v[228:229], v228
    ds_read_b64 v[230:231], v230
    ds_read_b64 v[232:233], v232
    buffer_load_dwordx4 v[234:237], v1, s[12:15], s28 offen offset:0 sc1
    s_waitcnt lgkmcnt(4)
    v_smfmac_f32_16x16x64_bf16 v[98:101], v[250:253], v[218:225], v254
    s_waitcnt vmcnt(3)
    v_lshlrev_b32_sdwa v218, 3, v238 dst_sel:DWORD dst_unused:UNUSED_PAD src0_sel:DWORD src1_sel:WORD_0
    v_lshlrev_b32_sdwa v220, 3, v238 dst_sel:DWORD dst_unused:UNUSED_PAD src0_sel:DWORD src1_sel:WORD_1
    v_lshlrev_b32_sdwa v222, 3, v239 dst_sel:DWORD dst_unused:UNUSED_PAD src0_sel:DWORD src1_sel:WORD_0
    v_lshlrev_b32_sdwa v224, 3, v239 dst_sel:DWORD dst_unused:UNUSED_PAD src0_sel:DWORD src1_sel:WORD_1
    v_mfma_f32_32x32x16_bf16 v[178:193], v[22:25], v[134:137], v[178:193]
    v_mfma_f32_32x32x16_bf16 v[194:209], v[22:25], v[150:153], v[194:209]
    ds_read_b64 v[218:219], v218
    ds_read_b64 v[220:221], v220
    ds_read_b64 v[222:223], v222
    ds_read_b64 v[224:225], v224
    s_waitcnt lgkmcnt(4)
    v_smfmac_f32_16x16x64_bf16 v[98:101], v[250:253], v[226:233], v254
    v_lshlrev_b32_sdwa v226, 3, v240 dst_sel:DWORD dst_unused:UNUSED_PAD src0_sel:DWORD src1_sel:WORD_0
    v_lshlrev_b32_sdwa v228, 3, v240 dst_sel:DWORD dst_unused:UNUSED_PAD src0_sel:DWORD src1_sel:WORD_1
    v_lshlrev_b32_sdwa v230, 3, v241 dst_sel:DWORD dst_unused:UNUSED_PAD src0_sel:DWORD src1_sel:WORD_0
    v_lshlrev_b32_sdwa v232, 3, v241 dst_sel:DWORD dst_unused:UNUSED_PAD src0_sel:DWORD src1_sel:WORD_1
    v_mfma_f32_32x32x16_bf16 v[178:193], v[26:29], v[138:141], v[178:193]
    v_mfma_f32_32x32x16_bf16 v[194:209], v[26:29], v[154:157], v[194:209]
    ds_read_b64 v[226:227], v226
    ds_read_b64 v[228:229], v228
    ds_read_b64 v[230:231], v230
    ds_read_b64 v[232:233], v232
    buffer_load_dwordx4 v[238:241], v1, s[12:15], s28 offen offset:1024 sc1
    s_waitcnt lgkmcnt(4)
    v_smfmac_f32_16x16x64_bf16 v[98:101], v[250:253], v[218:225], v254
    s_waitcnt vmcnt(3)
    v_lshlrev_b32_sdwa v218, 3, v242 dst_sel:DWORD dst_unused:UNUSED_PAD src0_sel:DWORD src1_sel:WORD_0
    v_lshlrev_b32_sdwa v220, 3, v242 dst_sel:DWORD dst_unused:UNUSED_PAD src0_sel:DWORD src1_sel:WORD_1
    v_lshlrev_b32_sdwa v222, 3, v243 dst_sel:DWORD dst_unused:UNUSED_PAD src0_sel:DWORD src1_sel:WORD_0
    v_lshlrev_b32_sdwa v224, 3, v243 dst_sel:DWORD dst_unused:UNUSED_PAD src0_sel:DWORD src1_sel:WORD_1
    v_mfma_f32_32x32x16_bf16 v[178:193], v[30:33], v[142:145], v[178:193]
    v_mfma_f32_32x32x16_bf16 v[194:209], v[30:33], v[158:161], v[194:209]
    ds_read_b64 v[218:219], v218
    ds_read_b64 v[220:221], v220
    ds_read_b64 v[222:223], v222
    ds_read_b64 v[224:225], v224
    s_waitcnt lgkmcnt(4)
    v_smfmac_f32_16x16x64_bf16 v[98:101], v[250:253], v[226:233], v254
    v_lshlrev_b32_sdwa v226, 3, v244 dst_sel:DWORD dst_unused:UNUSED_PAD src0_sel:DWORD src1_sel:WORD_0
    v_lshlrev_b32_sdwa v228, 3, v244 dst_sel:DWORD dst_unused:UNUSED_PAD src0_sel:DWORD src1_sel:WORD_1
    v_lshlrev_b32_sdwa v230, 3, v245 dst_sel:DWORD dst_unused:UNUSED_PAD src0_sel:DWORD src1_sel:WORD_0
    v_lshlrev_b32_sdwa v232, 3, v245 dst_sel:DWORD dst_unused:UNUSED_PAD src0_sel:DWORD src1_sel:WORD_1
    ds_read_b64 v[226:227], v226
    ds_read_b64 v[228:229], v228
    ds_read_b64 v[230:231], v230
    ds_read_b64 v[232:233], v232
    buffer_load_dwordx4 v[242:245], v1, s[12:15], s28 offen offset:2048 sc1
    s_waitcnt lgkmcnt(4)
    v_smfmac_f32_16x16x64_bf16 v[102:105], v[250:253], v[218:225], v254
    s_waitcnt vmcnt(3)
    v_lshlrev_b32_sdwa v218, 3, v246 dst_sel:DWORD dst_unused:UNUSED_PAD src0_sel:DWORD src1_sel:WORD_0
    v_lshlrev_b32_sdwa v220, 3, v246 dst_sel:DWORD dst_unused:UNUSED_PAD src0_sel:DWORD src1_sel:WORD_1
    v_lshlrev_b32_sdwa v222, 3, v247 dst_sel:DWORD dst_unused:UNUSED_PAD src0_sel:DWORD src1_sel:WORD_0
    v_lshlrev_b32_sdwa v224, 3, v247 dst_sel:DWORD dst_unused:UNUSED_PAD src0_sel:DWORD src1_sel:WORD_1
    v_cvt_pk_bf16_f32 v178, v178, v194
    v_cvt_pk_bf16_f32 v179, v179, v195
    v_cvt_pk_bf16_f32 v180, v180, v196
    v_cvt_pk_bf16_f32 v181, v181, v197
    v_cvt_pk_bf16_f32 v182, v182, v198
    ds_read_b64 v[218:219], v218
    ds_read_b64 v[220:221], v220
    ds_read_b64 v[222:223], v222
    ds_read_b64 v[224:225], v224
    s_waitcnt lgkmcnt(4)
    v_smfmac_f32_16x16x64_bf16 v[102:105], v[250:253], v[226:233], v254
    v_lshlrev_b32_sdwa v226, 3, v248 dst_sel:DWORD dst_unused:UNUSED_PAD src0_sel:DWORD src1_sel:WORD_0
    v_lshlrev_b32_sdwa v228, 3, v248 dst_sel:DWORD dst_unused:UNUSED_PAD src0_sel:DWORD src1_sel:WORD_1
    v_lshlrev_b32_sdwa v230, 3, v249 dst_sel:DWORD dst_unused:UNUSED_PAD src0_sel:DWORD src1_sel:WORD_0
    v_lshlrev_b32_sdwa v232, 3, v249 dst_sel:DWORD dst_unused:UNUSED_PAD src0_sel:DWORD src1_sel:WORD_1
    v_cvt_pk_bf16_f32 v183, v183, v199
    v_cvt_pk_bf16_f32 v184, v184, v200
    v_cvt_pk_bf16_f32 v185, v185, v201
    v_cvt_pk_bf16_f32 v186, v186, v202
    v_cvt_pk_bf16_f32 v187, v187, v203
    ds_read_b64 v[226:227], v226
    ds_read_b64 v[228:229], v228
    ds_read_b64 v[230:231], v230
    ds_read_b64 v[232:233], v232
    buffer_load_dwordx4 v[246:249], v1, s[12:15], s28 offen offset:3072 sc1
    s_add_u32 s28, s28, 4096
    s_waitcnt lgkmcnt(4)
    v_smfmac_f32_16x16x64_bf16 v[102:105], v[250:253], v[218:225], v254
    s_waitcnt vmcnt(3)
    v_lshlrev_b32_sdwa v218, 3, v234 dst_sel:DWORD dst_unused:UNUSED_PAD src0_sel:DWORD src1_sel:WORD_0
    v_lshlrev_b32_sdwa v220, 3, v234 dst_sel:DWORD dst_unused:UNUSED_PAD src0_sel:DWORD src1_sel:WORD_1
    v_lshlrev_b32_sdwa v222, 3, v235 dst_sel:DWORD dst_unused:UNUSED_PAD src0_sel:DWORD src1_sel:WORD_0
    v_lshlrev_b32_sdwa v224, 3, v235 dst_sel:DWORD dst_unused:UNUSED_PAD src0_sel:DWORD src1_sel:WORD_1
    v_cvt_pk_bf16_f32 v188, v188, v204
    v_cvt_pk_bf16_f32 v189, v189, v205
    v_cvt_pk_bf16_f32 v190, v190, v206
    v_cvt_pk_bf16_f32 v191, v191, v207
    v_cvt_pk_bf16_f32 v192, v192, v208
    ds_read_b64 v[218:219], v218
    ds_read_b64 v[220:221], v220
    ds_read_b64 v[222:223], v222
    ds_read_b64 v[224:225], v224
    s_waitcnt lgkmcnt(4)
    v_smfmac_f32_16x16x64_bf16 v[102:105], v[250:253], v[226:233], v254
    v_lshlrev_b32_sdwa v226, 3, v236 dst_sel:DWORD dst_unused:UNUSED_PAD src0_sel:DWORD src1_sel:WORD_0
    v_lshlrev_b32_sdwa v228, 3, v236 dst_sel:DWORD dst_unused:UNUSED_PAD src0_sel:DWORD src1_sel:WORD_1
    v_lshlrev_b32_sdwa v230, 3, v237 dst_sel:DWORD dst_unused:UNUSED_PAD src0_sel:DWORD src1_sel:WORD_0
    v_lshlrev_b32_sdwa v232, 3, v237 dst_sel:DWORD dst_unused:UNUSED_PAD src0_sel:DWORD src1_sel:WORD_1
    v_cvt_pk_bf16_f32 v193, v193, v209
    v_mfma_f32_32x32x16_bf16 v[194:209], v[34:37], v[130:133], 0
    v_mfma_f32_32x32x16_bf16 v[194:209], v[38:41], v[134:137], v[194:209]
    ds_read_b64 v[226:227], v226
    ds_read_b64 v[228:229], v228
    ds_read_b64 v[230:231], v230
    ds_read_b64 v[232:233], v232
    buffer_load_dwordx4 v[234:237], v1, s[12:15], s28 offen offset:0 sc1
    s_waitcnt lgkmcnt(4)
    v_smfmac_f32_16x16x64_bf16 v[106:109], v[250:253], v[218:225], v254
    s_waitcnt vmcnt(3)
    v_lshlrev_b32_sdwa v218, 3, v238 dst_sel:DWORD dst_unused:UNUSED_PAD src0_sel:DWORD src1_sel:WORD_0
    v_lshlrev_b32_sdwa v220, 3, v238 dst_sel:DWORD dst_unused:UNUSED_PAD src0_sel:DWORD src1_sel:WORD_1
    v_lshlrev_b32_sdwa v222, 3, v239 dst_sel:DWORD dst_unused:UNUSED_PAD src0_sel:DWORD src1_sel:WORD_0
    v_lshlrev_b32_sdwa v224, 3, v239 dst_sel:DWORD dst_unused:UNUSED_PAD src0_sel:DWORD src1_sel:WORD_1
    v_mfma_f32_32x32x16_bf16 v[194:209], v[42:45], v[138:141], v[194:209]
    v_mfma_f32_32x32x16_bf16 v[194:209], v[46:49], v[142:145], v[194:209]
    ds_read_b64 v[218:219], v218
    ds_read_b64 v[220:221], v220
    ds_read_b64 v[222:223], v222
    ds_read_b64 v[224:225], v224
    s_setprio 1
    s_waitcnt lgkmcnt(4)
    v_smfmac_f32_16x16x64_bf16 v[106:109], v[250:253], v[226:233], v254
    v_lshlrev_b32_sdwa v226, 3, v240 dst_sel:DWORD dst_unused:UNUSED_PAD src0_sel:DWORD src1_sel:WORD_0
    v_lshlrev_b32_sdwa v228, 3, v240 dst_sel:DWORD dst_unused:UNUSED_PAD src0_sel:DWORD src1_sel:WORD_1
    v_lshlrev_b32_sdwa v230, 3, v241 dst_sel:DWORD dst_unused:UNUSED_PAD src0_sel:DWORD src1_sel:WORD_0
    v_lshlrev_b32_sdwa v232, 3, v241 dst_sel:DWORD dst_unused:UNUSED_PAD src0_sel:DWORD src1_sel:WORD_1
    ds_read_b64 v[226:227], v226
    ds_read_b64 v[228:229], v228
    ds_read_b64 v[230:231], v230
    ds_read_b64 v[232:233], v232
    buffer_load_dwordx4 v[238:241], v1, s[12:15], s28 offen offset:1024 sc1
    s_waitcnt lgkmcnt(4)
    v_smfmac_f32_16x16x64_bf16 v[106:109], v[250:253], v[218:225], v254
    s_waitcnt vmcnt(3)
    v_lshlrev_b32_sdwa v218, 3, v242 dst_sel:DWORD dst_unused:UNUSED_PAD src0_sel:DWORD src1_sel:WORD_0
    v_lshlrev_b32_sdwa v220, 3, v242 dst_sel:DWORD dst_unused:UNUSED_PAD src0_sel:DWORD src1_sel:WORD_1
    v_lshlrev_b32_sdwa v222, 3, v243 dst_sel:DWORD dst_unused:UNUSED_PAD src0_sel:DWORD src1_sel:WORD_0
    v_lshlrev_b32_sdwa v224, 3, v243 dst_sel:DWORD dst_unused:UNUSED_PAD src0_sel:DWORD src1_sel:WORD_1
    v_cvt_pk_bf16_f32 v210, v194, v195
    v_cvt_pk_bf16_f32 v211, v196, v197
    v_cvt_pk_bf16_f32 v212, v198, v199
    v_cvt_pk_bf16_f32 v213, v200, v201
    v_cvt_pk_bf16_f32 v214, v202, v203
    ds_read_b64 v[218:219], v218
    ds_read_b64 v[220:221], v220
    ds_read_b64 v[222:223], v222
    ds_read_b64 v[224:225], v224
    s_waitcnt lgkmcnt(4)
    v_smfmac_f32_16x16x64_bf16 v[106:109], v[250:253], v[226:233], v254
    v_lshlrev_b32_sdwa v226, 3, v244 dst_sel:DWORD dst_unused:UNUSED_PAD src0_sel:DWORD src1_sel:WORD_0
    v_lshlrev_b32_sdwa v228, 3, v244 dst_sel:DWORD dst_unused:UNUSED_PAD src0_sel:DWORD src1_sel:WORD_1
    v_lshlrev_b32_sdwa v230, 3, v245 dst_sel:DWORD dst_unused:UNUSED_PAD src0_sel:DWORD src1_sel:WORD_0
    v_lshlrev_b32_sdwa v232, 3, v245 dst_sel:DWORD dst_unused:UNUSED_PAD src0_sel:DWORD src1_sel:WORD_1
    v_cvt_pk_bf16_f32 v215, v204, v205
    v_cvt_pk_bf16_f32 v216, v206, v207
    v_cvt_pk_bf16_f32 v217, v208, v209
    v_mfma_f32_32x32x16_bf16 v[194:209], v[50:53], v[130:133], 0
    v_mfma_f32_32x32x16_bf16 v[194:209], v[54:57], v[134:137], v[194:209]
    ds_read_b64 v[226:227], v226
    ds_read_b64 v[228:229], v228
    ds_read_b64 v[230:231], v230
    ds_read_b64 v[232:233], v232
    buffer_load_dwordx4 v[242:245], v1, s[12:15], s28 offen offset:2048 sc1
    s_waitcnt lgkmcnt(4)
    v_smfmac_f32_16x16x64_bf16 v[110:113], v[250:253], v[218:225], v254
    s_waitcnt vmcnt(3)
    v_lshlrev_b32_sdwa v218, 3, v246 dst_sel:DWORD dst_unused:UNUSED_PAD src0_sel:DWORD src1_sel:WORD_0
    v_lshlrev_b32_sdwa v220, 3, v246 dst_sel:DWORD dst_unused:UNUSED_PAD src0_sel:DWORD src1_sel:WORD_1
    v_lshlrev_b32_sdwa v222, 3, v247 dst_sel:DWORD dst_unused:UNUSED_PAD src0_sel:DWORD src1_sel:WORD_0
    v_lshlrev_b32_sdwa v224, 3, v247 dst_sel:DWORD dst_unused:UNUSED_PAD src0_sel:DWORD src1_sel:WORD_1
    v_mfma_f32_32x32x16_bf16 v[194:209], v[58:61], v[138:141], v[194:209]
    v_mfma_f32_32x32x16_bf16 v[194:209], v[62:65], v[142:145], v[194:209]
    ds_read_b64 v[218:219], v218
    ds_read_b64 v[220:221], v220
    ds_read_b64 v[222:223], v222
    ds_read_b64 v[224:225], v224
    s_waitcnt lgkmcnt(4)
    v_smfmac_f32_16x16x64_bf16 v[110:113], v[250:253], v[226:233], v254
    v_lshlrev_b32_sdwa v226, 3, v248 dst_sel:DWORD dst_unused:UNUSED_PAD src0_sel:DWORD src1_sel:WORD_0
    v_lshlrev_b32_sdwa v228, 3, v248 dst_sel:DWORD dst_unused:UNUSED_PAD src0_sel:DWORD src1_sel:WORD_1
    v_lshlrev_b32_sdwa v230, 3, v249 dst_sel:DWORD dst_unused:UNUSED_PAD src0_sel:DWORD src1_sel:WORD_0
    v_lshlrev_b32_sdwa v232, 3, v249 dst_sel:DWORD dst_unused:UNUSED_PAD src0_sel:DWORD src1_sel:WORD_1
    v_mfma_f32_32x32x16_bf16 v[130:145], v[34:37], v[146:149], 0
    v_mfma_f32_32x32x16_bf16 v[130:145], v[38:41], v[150:153], v[130:145]
    ds_read_b64 v[226:227], v226
    ds_read_b64 v[228:229], v228
    ds_read_b64 v[230:231], v230
    ds_read_b64 v[232:233], v232
    buffer_load_dwordx4 v[246:249], v1, s[12:15], s28 offen offset:3072 sc1
    s_add_u32 s28, s28, 4096
    s_waitcnt lgkmcnt(4)
    v_smfmac_f32_16x16x64_bf16 v[110:113], v[250:253], v[218:225], v254
    s_waitcnt vmcnt(3)
    v_lshlrev_b32_sdwa v218, 3, v234 dst_sel:DWORD dst_unused:UNUSED_PAD src0_sel:DWORD src1_sel:WORD_0
    v_lshlrev_b32_sdwa v220, 3, v234 dst_sel:DWORD dst_unused:UNUSED_PAD src0_sel:DWORD src1_sel:WORD_1
    v_lshlrev_b32_sdwa v222, 3, v235 dst_sel:DWORD dst_unused:UNUSED_PAD src0_sel:DWORD src1_sel:WORD_0
    v_lshlrev_b32_sdwa v224, 3, v235 dst_sel:DWORD dst_unused:UNUSED_PAD src0_sel:DWORD src1_sel:WORD_1
    v_cvt_pk_bf16_f32 v194, v194, v195
    v_cvt_pk_bf16_f32 v195, v196, v197
    v_cvt_pk_bf16_f32 v196, v198, v199
    v_cvt_pk_bf16_f32 v197, v200, v201
    v_cvt_pk_bf16_f32 v198, v202, v203
    v_mfma_f32_32x32x16_bf16 v[130:145], v[42:45], v[154:157], v[130:145]
    v_mfma_f32_32x32x16_bf16 v[130:145], v[46:49], v[158:161], v[130:145]
    ds_read_b64 v[218:219], v218
    ds_read_b64 v[220:221], v220
    ds_read_b64 v[222:223], v222
    ds_read_b64 v[224:225], v224
    s_waitcnt lgkmcnt(4)
    v_smfmac_f32_16x16x64_bf16 v[110:113], v[250:253], v[226:233], v254
    v_lshlrev_b32_sdwa v226, 3, v236 dst_sel:DWORD dst_unused:UNUSED_PAD src0_sel:DWORD src1_sel:WORD_0
    v_lshlrev_b32_sdwa v228, 3, v236 dst_sel:DWORD dst_unused:UNUSED_PAD src0_sel:DWORD src1_sel:WORD_1
    v_lshlrev_b32_sdwa v230, 3, v237 dst_sel:DWORD dst_unused:UNUSED_PAD src0_sel:DWORD src1_sel:WORD_0
    v_lshlrev_b32_sdwa v232, 3, v237 dst_sel:DWORD dst_unused:UNUSED_PAD src0_sel:DWORD src1_sel:WORD_1
    v_cvt_pk_bf16_f32 v199, v204, v205
    v_cvt_pk_bf16_f32 v200, v206, v207
    v_cvt_pk_bf16_f32 v201, v208, v209
    ds_read_b64 v[226:227], v226
    ds_read_b64 v[228:229], v228
    ds_read_b64 v[230:231], v230
    ds_read_b64 v[232:233], v232
    buffer_load_dwordx4 v[234:237], v1, s[12:15], s28 offen offset:0 sc1
    s_waitcnt lgkmcnt(4)
    v_smfmac_f32_16x16x64_bf16 v[114:117], v[250:253], v[218:225], v254
    s_waitcnt vmcnt(3)
    v_lshlrev_b32_sdwa v218, 3, v238 dst_sel:DWORD dst_unused:UNUSED_PAD src0_sel:DWORD src1_sel:WORD_0
    v_lshlrev_b32_sdwa v220, 3, v238 dst_sel:DWORD dst_unused:UNUSED_PAD src0_sel:DWORD src1_sel:WORD_1
    v_lshlrev_b32_sdwa v222, 3, v239 dst_sel:DWORD dst_unused:UNUSED_PAD src0_sel:DWORD src1_sel:WORD_0
    v_lshlrev_b32_sdwa v224, 3, v239 dst_sel:DWORD dst_unused:UNUSED_PAD src0_sel:DWORD src1_sel:WORD_1
    v_cvt_pk_bf16_f32 v130, v130, v131
    v_cvt_pk_bf16_f32 v131, v132, v133
    v_cvt_pk_bf16_f32 v132, v134, v135
    v_cvt_pk_bf16_f32 v133, v136, v137
    v_cvt_pk_bf16_f32 v134, v138, v139
    ds_read_b64 v[218:219], v218
    ds_read_b64 v[220:221], v220
    ds_read_b64 v[222:223], v222
    ds_read_b64 v[224:225], v224
    s_waitcnt lgkmcnt(4)
    v_smfmac_f32_16x16x64_bf16 v[114:117], v[250:253], v[226:233], v254
    v_lshlrev_b32_sdwa v226, 3, v240 dst_sel:DWORD dst_unused:UNUSED_PAD src0_sel:DWORD src1_sel:WORD_0
    v_lshlrev_b32_sdwa v228, 3, v240 dst_sel:DWORD dst_unused:UNUSED_PAD src0_sel:DWORD src1_sel:WORD_1
    v_lshlrev_b32_sdwa v230, 3, v241 dst_sel:DWORD dst_unused:UNUSED_PAD src0_sel:DWORD src1_sel:WORD_0
    v_lshlrev_b32_sdwa v232, 3, v241 dst_sel:DWORD dst_unused:UNUSED_PAD src0_sel:DWORD src1_sel:WORD_1
    v_cvt_pk_bf16_f32 v135, v140, v141
    v_cvt_pk_bf16_f32 v136, v142, v143
    v_cvt_pk_bf16_f32 v137, v144, v145
    v_perm_b32 v145, v137, v217, s67
    v_perm_b32 v144, v137, v217, s66
    ds_read_b64 v[226:227], v226
    ds_read_b64 v[228:229], v228
    ds_read_b64 v[230:231], v230
    ds_read_b64 v[232:233], v232
    buffer_load_dwordx4 v[238:241], v1, s[12:15], s28 offen offset:1024 sc1
    s_waitcnt lgkmcnt(4)
    v_smfmac_f32_16x16x64_bf16 v[114:117], v[250:253], v[218:225], v254
    s_waitcnt vmcnt(3)
    v_lshlrev_b32_sdwa v218, 3, v242 dst_sel:DWORD dst_unused:UNUSED_PAD src0_sel:DWORD src1_sel:WORD_0
    v_lshlrev_b32_sdwa v220, 3, v242 dst_sel:DWORD dst_unused:UNUSED_PAD src0_sel:DWORD src1_sel:WORD_1
    v_lshlrev_b32_sdwa v222, 3, v243 dst_sel:DWORD dst_unused:UNUSED_PAD src0_sel:DWORD src1_sel:WORD_0
    v_lshlrev_b32_sdwa v224, 3, v243 dst_sel:DWORD dst_unused:UNUSED_PAD src0_sel:DWORD src1_sel:WORD_1
    v_perm_b32 v143, v136, v216, s67
    v_perm_b32 v142, v136, v216, s66
    v_perm_b32 v141, v135, v215, s67
    v_perm_b32 v140, v135, v215, s66
    v_perm_b32 v139, v134, v214, s67
    ds_read_b64 v[218:219], v218
    ds_read_b64 v[220:221], v220
    ds_read_b64 v[222:223], v222
    ds_read_b64 v[224:225], v224
    s_waitcnt lgkmcnt(4)
    v_smfmac_f32_16x16x64_bf16 v[114:117], v[250:253], v[226:233], v254
    v_lshlrev_b32_sdwa v226, 3, v244 dst_sel:DWORD dst_unused:UNUSED_PAD src0_sel:DWORD src1_sel:WORD_0
    v_lshlrev_b32_sdwa v228, 3, v244 dst_sel:DWORD dst_unused:UNUSED_PAD src0_sel:DWORD src1_sel:WORD_1
    v_lshlrev_b32_sdwa v230, 3, v245 dst_sel:DWORD dst_unused:UNUSED_PAD src0_sel:DWORD src1_sel:WORD_0
    v_lshlrev_b32_sdwa v232, 3, v245 dst_sel:DWORD dst_unused:UNUSED_PAD src0_sel:DWORD src1_sel:WORD_1
    v_perm_b32 v138, v134, v214, s66
    v_perm_b32 v137, v133, v213, s67
    v_perm_b32 v136, v133, v213, s66
    v_perm_b32 v135, v132, v212, s67
    v_perm_b32 v134, v132, v212, s66
    ds_read_b64 v[226:227], v226
    ds_read_b64 v[228:229], v228
    ds_read_b64 v[230:231], v230
    ds_read_b64 v[232:233], v232
    buffer_load_dwordx4 v[242:245], v1, s[12:15], s28 offen offset:2048 sc1
    s_setprio 0
    s_waitcnt lgkmcnt(4)
    v_smfmac_f32_16x16x64_bf16 v[118:121], v[250:253], v[218:225], v254
    s_waitcnt vmcnt(3)
    v_lshlrev_b32_sdwa v218, 3, v246 dst_sel:DWORD dst_unused:UNUSED_PAD src0_sel:DWORD src1_sel:WORD_0
    v_lshlrev_b32_sdwa v220, 3, v246 dst_sel:DWORD dst_unused:UNUSED_PAD src0_sel:DWORD src1_sel:WORD_1
    v_lshlrev_b32_sdwa v222, 3, v247 dst_sel:DWORD dst_unused:UNUSED_PAD src0_sel:DWORD src1_sel:WORD_0
    v_lshlrev_b32_sdwa v224, 3, v247 dst_sel:DWORD dst_unused:UNUSED_PAD src0_sel:DWORD src1_sel:WORD_1
    v_perm_b32 v133, v131, v211, s67
    v_perm_b32 v132, v131, v211, s66
    v_perm_b32 v131, v130, v210, s67
    v_perm_b32 v130, v130, v210, s66
    v_mov_b32 v210, v194
    ds_read_b64 v[218:219], v218
    ds_read_b64 v[220:221], v220
    ds_read_b64 v[222:223], v222
    ds_read_b64 v[224:225], v224
    s_waitcnt lgkmcnt(4)
    v_smfmac_f32_16x16x64_bf16 v[118:121], v[250:253], v[226:233], v254
    v_lshlrev_b32_sdwa v226, 3, v248 dst_sel:DWORD dst_unused:UNUSED_PAD src0_sel:DWORD src1_sel:WORD_0
    v_lshlrev_b32_sdwa v228, 3, v248 dst_sel:DWORD dst_unused:UNUSED_PAD src0_sel:DWORD src1_sel:WORD_1
    v_lshlrev_b32_sdwa v230, 3, v249 dst_sel:DWORD dst_unused:UNUSED_PAD src0_sel:DWORD src1_sel:WORD_0
    v_lshlrev_b32_sdwa v232, 3, v249 dst_sel:DWORD dst_unused:UNUSED_PAD src0_sel:DWORD src1_sel:WORD_1
    v_mov_b32 v211, v195
    v_mov_b32 v212, v196
    v_mov_b32 v213, v197
    v_mov_b32 v214, v198
    v_mov_b32 v215, v199
    ds_read_b64 v[226:227], v226
    ds_read_b64 v[228:229], v228
    ds_read_b64 v[230:231], v230
    ds_read_b64 v[232:233], v232
    buffer_load_dwordx4 v[246:249], v1, s[12:15], s28 offen offset:3072 sc1
    s_add_u32 s28, s28, 4096
    s_add_u32 s28, s28, s47
    s_waitcnt lgkmcnt(4)
    v_smfmac_f32_16x16x64_bf16 v[118:121], v[250:253], v[218:225], v254
    s_waitcnt vmcnt(3)
    v_lshlrev_b32_sdwa v218, 3, v234 dst_sel:DWORD dst_unused:UNUSED_PAD src0_sel:DWORD src1_sel:WORD_0
    v_lshlrev_b32_sdwa v220, 3, v234 dst_sel:DWORD dst_unused:UNUSED_PAD src0_sel:DWORD src1_sel:WORD_1
    v_lshlrev_b32_sdwa v222, 3, v235 dst_sel:DWORD dst_unused:UNUSED_PAD src0_sel:DWORD src1_sel:WORD_0
    v_lshlrev_b32_sdwa v224, 3, v235 dst_sel:DWORD dst_unused:UNUSED_PAD src0_sel:DWORD src1_sel:WORD_1
    v_mov_b32 v216, v200
    v_mov_b32 v217, v201
    v_mfma_f32_32x32x16_bf16 v[194:209], v[50:53], v[146:149], 0
    v_mfma_f32_32x32x16_bf16 v[194:209], v[54:57], v[150:153], v[194:209]
    ds_read_b64 v[218:219], v218
    ds_read_b64 v[220:221], v220
    ds_read_b64 v[222:223], v222
    ds_read_b64 v[224:225], v224
    s_waitcnt lgkmcnt(4)
    v_smfmac_f32_16x16x64_bf16 v[118:121], v[250:253], v[226:233], v254
    v_lshlrev_b32_sdwa v226, 3, v236 dst_sel:DWORD dst_unused:UNUSED_PAD src0_sel:DWORD src1_sel:WORD_0
    v_lshlrev_b32_sdwa v228, 3, v236 dst_sel:DWORD dst_unused:UNUSED_PAD src0_sel:DWORD src1_sel:WORD_1
    v_lshlrev_b32_sdwa v230, 3, v237 dst_sel:DWORD dst_unused:UNUSED_PAD src0_sel:DWORD src1_sel:WORD_0
    v_lshlrev_b32_sdwa v232, 3, v237 dst_sel:DWORD dst_unused:UNUSED_PAD src0_sel:DWORD src1_sel:WORD_1
    v_mfma_f32_32x32x16_bf16 v[194:209], v[58:61], v[154:157], v[194:209]
    v_mfma_f32_32x32x16_bf16 v[194:209], v[62:65], v[158:161], v[194:209]
    ds_read_b64 v[226:227], v226
    ds_read_b64 v[228:229], v228
    ds_read_b64 v[230:231], v230
    ds_read_b64 v[232:233], v232
    buffer_load_dwordx4 v[234:237], v1, s[12:15], s28 offen offset:0 sc1
    s_waitcnt lgkmcnt(4)
    v_smfmac_f32_16x16x64_bf16 v[122:125], v[250:253], v[218:225], v254
    s_waitcnt vmcnt(3)
    v_lshlrev_b32_sdwa v218, 3, v238 dst_sel:DWORD dst_unused:UNUSED_PAD src0_sel:DWORD src1_sel:WORD_0
    v_lshlrev_b32_sdwa v220, 3, v238 dst_sel:DWORD dst_unused:UNUSED_PAD src0_sel:DWORD src1_sel:WORD_1
    v_lshlrev_b32_sdwa v222, 3, v239 dst_sel:DWORD dst_unused:UNUSED_PAD src0_sel:DWORD src1_sel:WORD_0
    v_lshlrev_b32_sdwa v224, 3, v239 dst_sel:DWORD dst_unused:UNUSED_PAD src0_sel:DWORD src1_sel:WORD_1
    ds_read_b64 v[218:219], v218
    ds_read_b64 v[220:221], v220
    ds_read_b64 v[222:223], v222
    ds_read_b64 v[224:225], v224
    buffer_load_dwordx4 v[146:149], v1, s[12:15], s26 offen sc1
    s_mov_b32 m0, s23
    s_waitcnt lgkmcnt(4)
    v_smfmac_f32_16x16x64_bf16 v[122:125], v[250:253], v[226:233], v254
    v_lshlrev_b32_sdwa v226, 3, v240 dst_sel:DWORD dst_unused:UNUSED_PAD src0_sel:DWORD src1_sel:WORD_0
    v_lshlrev_b32_sdwa v228, 3, v240 dst_sel:DWORD dst_unused:UNUSED_PAD src0_sel:DWORD src1_sel:WORD_1
    v_lshlrev_b32_sdwa v230, 3, v241 dst_sel:DWORD dst_unused:UNUSED_PAD src0_sel:DWORD src1_sel:WORD_0
    v_lshlrev_b32_sdwa v232, 3, v241 dst_sel:DWORD dst_unused:UNUSED_PAD src0_sel:DWORD src1_sel:WORD_1
    v_cvt_pk_bf16_f32 v194, v194, v195
    v_cvt_pk_bf16_f32 v195, v196, v197
    v_cvt_pk_bf16_f32 v196, v198, v199
    v_cvt_pk_bf16_f32 v197, v200, v201
    v_cvt_pk_bf16_f32 v198, v202, v203
    ds_read_b64 v[226:227], v226
    ds_read_b64 v[228:229], v228
    ds_read_b64 v[230:231], v230
    ds_read_b64 v[232:233], v232
    buffer_load_dwordx4 v[238:241], v1, s[12:15], s28 offen offset:1024 sc1
    s_waitcnt lgkmcnt(4)
    v_smfmac_f32_16x16x64_bf16 v[122:125], v[250:253], v[218:225], v254
    s_waitcnt vmcnt(4)
    v_lshlrev_b32_sdwa v218, 3, v242 dst_sel:DWORD dst_unused:UNUSED_PAD src0_sel:DWORD src1_sel:WORD_0
    v_lshlrev_b32_sdwa v220, 3, v242 dst_sel:DWORD dst_unused:UNUSED_PAD src0_sel:DWORD src1_sel:WORD_1
    v_lshlrev_b32_sdwa v222, 3, v243 dst_sel:DWORD dst_unused:UNUSED_PAD src0_sel:DWORD src1_sel:WORD_0
    v_lshlrev_b32_sdwa v224, 3, v243 dst_sel:DWORD dst_unused:UNUSED_PAD src0_sel:DWORD src1_sel:WORD_1
    v_cvt_pk_bf16_f32 v199, v204, v205
    v_cvt_pk_bf16_f32 v200, v206, v207
    v_cvt_pk_bf16_f32 v201, v208, v209
    v_perm_b32 v209, v201, v217, s67
    v_perm_b32 v208, v201, v217, s66
    ds_read_b64 v[218:219], v218
    ds_read_b64 v[220:221], v220
    ds_read_b64 v[222:223], v222
    ds_read_b64 v[224:225], v224
    s_waitcnt lgkmcnt(4)
    v_smfmac_f32_16x16x64_bf16 v[122:125], v[250:253], v[226:233], v254
    v_lshlrev_b32_sdwa v226, 3, v244 dst_sel:DWORD dst_unused:UNUSED_PAD src0_sel:DWORD src1_sel:WORD_0
    v_lshlrev_b32_sdwa v228, 3, v244 dst_sel:DWORD dst_unused:UNUSED_PAD src0_sel:DWORD src1_sel:WORD_1
    v_lshlrev_b32_sdwa v230, 3, v245 dst_sel:DWORD dst_unused:UNUSED_PAD src0_sel:DWORD src1_sel:WORD_0
    v_lshlrev_b32_sdwa v232, 3, v245 dst_sel:DWORD dst_unused:UNUSED_PAD src0_sel:DWORD src1_sel:WORD_1
    v_perm_b32 v207, v200, v216, s67
    v_perm_b32 v206, v200, v216, s66
    v_perm_b32 v205, v199, v215, s67
    v_perm_b32 v204, v199, v215, s66
    v_perm_b32 v203, v198, v214, s67
    ds_read_b64 v[226:227], v226
    ds_read_b64 v[228:229], v228
    ds_read_b64 v[230:231], v230
    ds_read_b64 v[232:233], v232
    buffer_load_dwordx4 v[242:245], v1, s[12:15], s28 offen offset:2048 sc1
    s_waitcnt lgkmcnt(4)
    v_smfmac_f32_16x16x64_bf16 v[126:129], v[250:253], v[218:225], v254
    s_waitcnt vmcnt(4)
    v_lshlrev_b32_sdwa v218, 3, v246 dst_sel:DWORD dst_unused:UNUSED_PAD src0_sel:DWORD src1_sel:WORD_0
    v_lshlrev_b32_sdwa v220, 3, v246 dst_sel:DWORD dst_unused:UNUSED_PAD src0_sel:DWORD src1_sel:WORD_1
    v_lshlrev_b32_sdwa v222, 3, v247 dst_sel:DWORD dst_unused:UNUSED_PAD src0_sel:DWORD src1_sel:WORD_0
    v_lshlrev_b32_sdwa v224, 3, v247 dst_sel:DWORD dst_unused:UNUSED_PAD src0_sel:DWORD src1_sel:WORD_1
    v_perm_b32 v202, v198, v214, s66
    v_perm_b32 v201, v197, v213, s67
    v_perm_b32 v200, v197, v213, s66
    v_perm_b32 v199, v196, v212, s67
    v_perm_b32 v198, v196, v212, s66
    ds_read_b64 v[218:219], v218
    ds_read_b64 v[220:221], v220
    ds_read_b64 v[222:223], v222
    ds_read_b64 v[224:225], v224
    s_waitcnt lgkmcnt(4)
    v_smfmac_f32_16x16x64_bf16 v[126:129], v[250:253], v[226:233], v254
    v_lshlrev_b32_sdwa v226, 3, v248 dst_sel:DWORD dst_unused:UNUSED_PAD src0_sel:DWORD src1_sel:WORD_0
    v_lshlrev_b32_sdwa v228, 3, v248 dst_sel:DWORD dst_unused:UNUSED_PAD src0_sel:DWORD src1_sel:WORD_1
    v_lshlrev_b32_sdwa v230, 3, v249 dst_sel:DWORD dst_unused:UNUSED_PAD src0_sel:DWORD src1_sel:WORD_0
    v_lshlrev_b32_sdwa v232, 3, v249 dst_sel:DWORD dst_unused:UNUSED_PAD src0_sel:DWORD src1_sel:WORD_1
    v_perm_b32 v197, v195, v211, s67
    v_perm_b32 v196, v195, v211, s66
    v_perm_b32 v195, v194, v210, s67
    v_perm_b32 v194, v194, v210, s66
    ds_read_b64 v[226:227], v226
    ds_read_b64 v[228:229], v228
    ds_read_b64 v[230:231], v230
    ds_read_b64 v[232:233], v232
    buffer_load_dwordx4 v[246:249], v1, s[12:15], s28 offen offset:3072 sc1
    s_add_u32 s28, s28, 4096
    s_waitcnt lgkmcnt(4)
    v_smfmac_f32_16x16x64_bf16 v[126:129], v[250:253], v[218:225], v254
    s_waitcnt lgkmcnt(0)
    s_barrier
    s_setprio 3
    ds_write_addtid_b32 v162 offset:0
    ds_write_addtid_b32 v163 offset:256
    ds_write_addtid_b32 v164 offset:512
    ds_write_addtid_b32 v165 offset:768
    v_smfmac_f32_16x16x64_bf16 v[126:129], v[250:253], v[226:233], v254
    ds_write_addtid_b32 v166 offset:1024
    ds_write_addtid_b32 v167 offset:1280
    ds_write_addtid_b32 v168 offset:1536
    ds_write_addtid_b32 v169 offset:1792
    ds_write_addtid_b32 v170 offset:2048
    v_add_u32 v217, s33, v1
    ds_write_addtid_b32 v171 offset:2304
    v_add_u32 v216, 131072, v1
    ds_write_addtid_b32 v172 offset:2560
    v_lshrrev_b32 v214, 3, v0
    ds_write_addtid_b32 v173 offset:2816
    v_lshlrev_b32 v214, 14, v214
    ds_write_addtid_b32 v174 offset:3072
    v_and_b32 v215, 7, v0
    ds_write_addtid_b32 v175 offset:3328
    v_lshl_add_u32 v214, v215, 4, v214
    ds_write_addtid_b32 v176 offset:3584
    v_mov_b32 v210, -1
    ds_write_addtid_b32 v177 offset:3840
    v_mov_b32 v211, -1
    s_setprio 2
    ds_write_addtid_b32 v178 offset:4096
    v_mov_b32 v212, -1
    ds_write_addtid_b32 v179 offset:4352
    v_mov_b32 v213, -1
    ds_write_addtid_b32 v180 offset:4608
    s_xor_b32 s27, s34, 64
    ds_write_addtid_b32 v181 offset:4864
    s_lshl_b32 s3, s27, 15
    ds_write_addtid_b32 v182 offset:5120
    s_lshl_b32 s20, s22, 12
    ds_write_addtid_b32 v183 offset:5376
    s_add_u32 s3, s3, s20
    ds_write_addtid_b32 v184 offset:5632
    s_add_u32 s3, s3, 20971520
    ds_write_addtid_b32 v185 offset:5888
    s_lshl_b32 s38, s27, 11
    ds_write_addtid_b32 v186 offset:6144
    s_lshl_b32 s20, s22, 8
    ds_write_addtid_b32 v187 offset:6400
    s_add_u32 s38, s38, s20
    ds_write_addtid_b32 v188 offset:6656
    s_add_u32 s38, s38, 17825792
    ds_write_addtid_b32 v189 offset:6912
    s_xor_b32 s39, s38, 0x20000
    ds_write_addtid_b32 v190 offset:7168
    s_xor_b32 s37, s3, 0x200000
    ds_write_addtid_b32 v191 offset:7424
    s_waitcnt vmcnt(4)
    ds_write_addtid_b32 v192 offset:7680
    v_lshlrev_b32_sdwa v218, 3, v234 dst_sel:DWORD dst_unused:UNUSED_PAD src0_sel:DWORD src1_sel:WORD_0
    ds_write_addtid_b32 v193 offset:7936
    v_lshlrev_b32_sdwa v220, 3, v234 dst_sel:DWORD dst_unused:UNUSED_PAD src0_sel:DWORD src1_sel:WORD_1
    s_setprio 1
    s_mov_b32 m0, s30
    s_nop 0
    ds_write_addtid_b32 v130 offset:57472
    v_lshlrev_b32_sdwa v222, 3, v235 dst_sel:DWORD dst_unused:UNUSED_PAD src0_sel:DWORD src1_sel:WORD_0
    ds_write_addtid_b32 v131 offset:57728
    v_lshlrev_b32_sdwa v224, 3, v235 dst_sel:DWORD dst_unused:UNUSED_PAD src0_sel:DWORD src1_sel:WORD_1
    ds_write_addtid_b32 v132 offset:57984
    v_lshlrev_b32_sdwa v226, 3, v236 dst_sel:DWORD dst_unused:UNUSED_PAD src0_sel:DWORD src1_sel:WORD_0
    ds_write_addtid_b32 v133 offset:58240
    v_lshlrev_b32_sdwa v228, 3, v236 dst_sel:DWORD dst_unused:UNUSED_PAD src0_sel:DWORD src1_sel:WORD_1
    ds_write_addtid_b32 v134 offset:58496
    v_lshlrev_b32_sdwa v230, 3, v237 dst_sel:DWORD dst_unused:UNUSED_PAD src0_sel:DWORD src1_sel:WORD_0
    ds_write_addtid_b32 v135 offset:58752
    v_lshlrev_b32_sdwa v232, 3, v237 dst_sel:DWORD dst_unused:UNUSED_PAD src0_sel:DWORD src1_sel:WORD_1
    ds_write_addtid_b32 v136 offset:59008
    ds_write_addtid_b32 v137 offset:59264
    ds_write_addtid_b32 v138 offset:59520
    ds_write_addtid_b32 v139 offset:59776
    ds_write_addtid_b32 v140 offset:60032
    ds_write_addtid_b32 v141 offset:60288
    ds_write_addtid_b32 v142 offset:60544
    ds_write_addtid_b32 v143 offset:60800
    ds_write_addtid_b32 v144 offset:61056
    ds_write_addtid_b32 v145 offset:61312
    s_setprio 0
    ds_write_addtid_b32 v194 offset:61568
    ds_write_addtid_b32 v195 offset:61824
    ds_write_addtid_b32 v196 offset:62080
    s_waitcnt vmcnt(0)
    ds_write_b128 v217, v[146:149]
    buffer_store_dwordx4 v[210:213], v214, s[12:15], s75 offen sc1
    buffer_store_dwordx4 v[210:213], v214, s[12:15], s75 offen offset:128 sc1
    s_mov_b64 exec, 0xffff
    buffer_store_dwordx4 v[210:213], v1, s[12:15], s38 offen sc1
    s_mov_b64 exec, -1
    buffer_load_dwordx4 v[234:237], v1, s[12:15], s28 offen sc1
    ds_write_addtid_b32 v197 offset:62336
    s_cmp_eq_u32 s22, 7
    s_cbranch_scc1 W_e0
    ds_write_addtid_b32 v198 offset:62592
    ds_write_addtid_b32 v199 offset:62848
    ds_write_addtid_b32 v200 offset:63104
    ds_write_addtid_b32 v201 offset:63360
    ds_write_addtid_b32 v202 offset:63616
    ds_write_addtid_b32 v203 offset:63872
    ds_write_addtid_b32 v204 offset:64128
    ds_write_addtid_b32 v205 offset:64384
    ds_write_addtid_b32 v206 offset:64640
    ds_write_addtid_b32 v207 offset:64896
    ds_write_addtid_b32 v208 offset:65152
    ds_write_addtid_b32 v209 offset:65408
W_e0:
    s_setprio 3
    s_waitcnt lgkmcnt(0)
    s_barrier
    ds_read_b128 v[130:133], v216 offset:0
    ds_read_b128 v[146:149], v216 offset:12800
    ds_read_b128 v[134:137], v216 offset:3200
    ds_read_b128 v[150:153], v216 offset:16000
    ds_read_b128 v[138:141], v216 offset:6400
    ds_read_b128 v[154:157], v216 offset:19200
    ds_read_b128 v[142:145], v216 offset:9600
    ds_read_b128 v[158:161], v216 offset:22400
    ds_read_b64 v[218:219], v218
    ds_read_b64 v[220:221], v220
    ds_read_b64 v[222:223], v222
    ds_read_b64 v[224:225], v224
    ds_read_b64 v[226:227], v226
    ds_read_b64 v[228:229], v228
    ds_read_b64 v[230:231], v230
    ds_read_b64 v[232:233], v232
    s_waitcnt lgkmcnt(4)
    v_smfmac_f32_16x16x64_bf16 v[66:69], v[250:253], v[218:225], v254
    s_waitcnt vmcnt(3)
    v_lshlrev_b32_sdwa v218, 3, v238 dst_sel:DWORD dst_unused:UNUSED_PAD src0_sel:DWORD src1_sel:WORD_0
    v_lshlrev_b32_sdwa v220, 3, v238 dst_sel:DWORD dst_unused:UNUSED_PAD src0_sel:DWORD src1_sel:WORD_1
    v_lshlrev_b32_sdwa v222, 3, v239 dst_sel:DWORD dst_unused:UNUSED_PAD src0_sel:DWORD src1_sel:WORD_0
    v_lshlrev_b32_sdwa v224, 3, v239 dst_sel:DWORD dst_unused:UNUSED_PAD src0_sel:DWORD src1_sel:WORD_1
    ds_read_b64 v[218:219], v218
    ds_read_b64 v[220:221], v220
    ds_read_b64 v[222:223], v222
    ds_read_b64 v[224:225], v224
    s_waitcnt lgkmcnt(4)
    v_smfmac_f32_16x16x64_bf16 v[66:69], v[250:253], v[226:233], v254
    v_lshlrev_b32_sdwa v226, 3, v240 dst_sel:DWORD dst_unused:UNUSED_PAD src0_sel:DWORD src1_sel:WORD_0
    v_lshlrev_b32_sdwa v228, 3, v240 dst_sel:DWORD dst_unused:UNUSED_PAD src0_sel:DWORD src1_sel:WORD_1
    v_lshlrev_b32_sdwa v230, 3, v241 dst_sel:DWORD dst_unused:UNUSED_PAD src0_sel:DWORD src1_sel:WORD_0
    v_lshlrev_b32_sdwa v232, 3, v241 dst_sel:DWORD dst_unused:UNUSED_PAD src0_sel:DWORD src1_sel:WORD_1
    ds_read_b64 v[226:227], v226
    ds_read_b64 v[228:229], v228
    ds_read_b64 v[230:231], v230
    ds_read_b64 v[232:233], v232
    buffer_load_dwordx4 v[238:241], v1, s[12:15], s28 offen offset:1024 sc1
    s_waitcnt lgkmcnt(4)
    v_smfmac_f32_16x16x64_bf16 v[66:69], v[250:253], v[218:225], v254
    s_waitcnt vmcnt(3)
    v_lshlrev_b32_sdwa v218, 3, v242 dst_sel:DWORD dst_unused:UNUSED_PAD src0_sel:DWORD src1_sel:WORD_0
    v_lshlrev_b32_sdwa v220, 3, v242 dst_sel:DWORD dst_unused:UNUSED_PAD src0_sel:DWORD src1_sel:WORD_1
    v_lshlrev_b32_sdwa v222, 3, v243 dst_sel:DWORD dst_unused:UNUSED_PAD src0_sel:DWORD src1_sel:WORD_0
    v_lshlrev_b32_sdwa v224, 3, v243 dst_sel:DWORD dst_unused:UNUSED_PAD src0_sel:DWORD src1_sel:WORD_1
    v_mfma_f32_32x32x16_bf16 v[178:193], v[2:5], v[130:133], 0
    ds_read_b64 v[218:219], v218
    ds_read_b64 v[220:221], v220
    ds_read_b64 v[222:223], v222
    ds_read_b64 v[224:225], v224
    s_lshl_b32 s26, s25, 16
    s_lshl_b32 s27, s22, 10
    s_add_u32 s26, s26, s27
    s_add_u32 s26, s26, 4243456
    s_waitcnt lgkmcnt(4)
    v_smfmac_f32_16x16x64_bf16 v[66:69], v[250:253], v[226:233], v254
    v_lshlrev_b32_sdwa v226, 3, v244 dst_sel:DWORD dst_unused:UNUSED_PAD src0_sel:DWORD src1_sel:WORD_0
    v_lshlrev_b32_sdwa v228, 3, v244 dst_sel:DWORD dst_unused:UNUSED_PAD src0_sel:DWORD src1_sel:WORD_1
    v_lshlrev_b32_sdwa v230, 3, v245 dst_sel:DWORD dst_unused:UNUSED_PAD src0_sel:DWORD src1_sel:WORD_0
    v_lshlrev_b32_sdwa v232, 3, v245 dst_sel:DWORD dst_unused:UNUSED_PAD src0_sel:DWORD src1_sel:WORD_1
    v_mfma_f32_32x32x16_bf16 v[194:209], v[2:5], v[146:149], 0
    ds_read_b64 v[226:227], v226
    ds_read_b64 v[228:229], v228
    ds_read_b64 v[230:231], v230
    ds_read_b64 v[232:233], v232
    buffer_load_dwordx4 v[242:245], v1, s[12:15], s28 offen offset:2048 sc1
    s_waitcnt lgkmcnt(4)
    v_smfmac_f32_16x16x64_bf16 v[70:73], v[250:253], v[218:225], v254
    s_waitcnt vmcnt(3)
    v_lshlrev_b32_sdwa v218, 3, v246 dst_sel:DWORD dst_unused:UNUSED_PAD src0_sel:DWORD src1_sel:WORD_0
    v_lshlrev_b32_sdwa v220, 3, v246 dst_sel:DWORD dst_unused:UNUSED_PAD src0_sel:DWORD src1_sel:WORD_1
    v_lshlrev_b32_sdwa v222, 3, v247 dst_sel:DWORD dst_unused:UNUSED_PAD src0_sel:DWORD src1_sel:WORD_0
    v_lshlrev_b32_sdwa v224, 3, v247 dst_sel:DWORD dst_unused:UNUSED_PAD src0_sel:DWORD src1_sel:WORD_1
    v_mfma_f32_32x32x16_bf16 v[178:193], v[6:9], v[134:137], v[178:193]
    ds_read_b64 v[218:219], v218
    ds_read_b64 v[220:221], v220
    ds_read_b64 v[222:223], v222
    ds_read_b64 v[224:225], v224
    s_waitcnt lgkmcnt(4)
    v_smfmac_f32_16x16x64_bf16 v[70:73], v[250:253], v[226:233], v254
    v_lshlrev_b32_sdwa v226, 3, v248 dst_sel:DWORD dst_unused:UNUSED_PAD src0_sel:DWORD src1_sel:WORD_0
    v_lshlrev_b32_sdwa v228, 3, v248 dst_sel:DWORD dst_unused:UNUSED_PAD src0_sel:DWORD src1_sel:WORD_1
    v_lshlrev_b32_sdwa v230, 3, v249 dst_sel:DWORD dst_unused:UNUSED_PAD src0_sel:DWORD src1_sel:WORD_0
    v_lshlrev_b32_sdwa v232, 3, v249 dst_sel:DWORD dst_unused:UNUSED_PAD src0_sel:DWORD src1_sel:WORD_1
    v_mfma_f32_32x32x16_bf16 v[194:209], v[6:9], v[150:153], v[194:209]
    ds_read_b64 v[226:227], v226
    ds_read_b64 v[228:229], v228
    ds_read_b64 v[230:231], v230
    ds_read_b64 v[232:233], v232
    buffer_load_dwordx4 v[246:249], v1, s[12:15], s28 offen offset:3072 sc1
    s_add_u32 s28, s28, 4096
    s_waitcnt lgkmcnt(4)
    v_smfmac_f32_16x16x64_bf16 v[70:73], v[250:253], v[218:225], v254
    s_waitcnt vmcnt(3)
    v_lshlrev_b32_sdwa v218, 3, v234 dst_sel:DWORD dst_unused:UNUSED_PAD src0_sel:DWORD src1_sel:WORD_0
    v_lshlrev_b32_sdwa v220, 3, v234 dst_sel:DWORD dst_unused:UNUSED_PAD src0_sel:DWORD src1_sel:WORD_1
    v_lshlrev_b32_sdwa v222, 3, v235 dst_sel:DWORD dst_unused:UNUSED_PAD src0_sel:DWORD src1_sel:WORD_0
    v_lshlrev_b32_sdwa v224, 3, v235 dst_sel:DWORD dst_unused:UNUSED_PAD src0_sel:DWORD src1_sel:WORD_1
    v_mfma_f32_32x32x16_bf16 v[178:193], v[10:13], v[138:141], v[178:193]
    ds_read_b64 v[218:219], v218
    ds_read_b64 v[220:221], v220
    ds_read_b64 v[222:223], v222
    ds_read_b64 v[224:225], v224
    s_waitcnt lgkmcnt(4)
    v_smfmac_f32_16x16x64_bf16 v[70:73], v[250:253], v[226:233], v254
    v_lshlrev_b32_sdwa v226, 3, v236 dst_sel:DWORD dst_unused:UNUSED_PAD src0_sel:DWORD src1_sel:WORD_0
    v_lshlrev_b32_sdwa v228, 3, v236 dst_sel:DWORD dst_unused:UNUSED_PAD src0_sel:DWORD src1_sel:WORD_1
    v_lshlrev_b32_sdwa v230, 3, v237 dst_sel:DWORD dst_unused:UNUSED_PAD src0_sel:DWORD src1_sel:WORD_0
    v_lshlrev_b32_sdwa v232, 3, v237 dst_sel:DWORD dst_unused:UNUSED_PAD src0_sel:DWORD src1_sel:WORD_1
    v_mfma_f32_32x32x16_bf16 v[194:209], v[10:13], v[154:157], v[194:209]
    ds_read_b64 v[226:227], v226
    ds_read_b64 v[228:229], v228
    ds_read_b64 v[230:231], v230
    ds_read_b64 v[232:233], v232
    buffer_load_dwordx4 v[234:237], v1, s[12:15], s28 offen offset:0 sc1
    s_waitcnt lgkmcnt(4)
    v_smfmac_f32_16x16x64_bf16 v[74:77], v[250:253], v[218:225], v254
    s_waitcnt vmcnt(3)
    v_lshlrev_b32_sdwa v218, 3, v238 dst_sel:DWORD dst_unused:UNUSED_PAD src0_sel:DWORD src1_sel:WORD_0
    v_lshlrev_b32_sdwa v220, 3, v238 dst_sel:DWORD dst_unused:UNUSED_PAD src0_sel:DWORD src1_sel:WORD_1
    v_lshlrev_b32_sdwa v222, 3, v239 dst_sel:DWORD dst_unused:UNUSED_PAD src0_sel:DWORD src1_sel:WORD_0
    v_lshlrev_b32_sdwa v224, 3, v239 dst_sel:DWORD dst_unused:UNUSED_PAD src0_sel:DWORD src1_sel:WORD_1
    v_mfma_f32_32x32x16_bf16 v[178:193], v[14:17], v[142:145], v[178:193]
    ds_read_b64 v[218:219], v218
    ds_read_b64 v[220:221], v220
    ds_read_b64 v[222:223], v222
    ds_read_b64 v[224:225], v224
    s_waitcnt lgkmcnt(4)
    v_smfmac_f32_16x16x64_bf16 v[74:77], v[250:253], v[226:233], v254
    v_lshlrev_b32_sdwa v226, 3, v240 dst_sel:DWORD dst_unused:UNUSED_PAD src0_sel:DWORD src1_sel:WORD_0
    v_lshlrev_b32_sdwa v228, 3, v240 dst_sel:DWORD dst_unused:UNUSED_PAD src0_sel:DWORD src1_sel:WORD_1
    v_lshlrev_b32_sdwa v230, 3, v241 dst_sel:DWORD dst_unused:UNUSED_PAD src0_sel:DWORD src1_sel:WORD_0
    v_lshlrev_b32_sdwa v232, 3, v241 dst_sel:DWORD dst_unused:UNUSED_PAD src0_sel:DWORD src1_sel:WORD_1
    v_mfma_f32_32x32x16_bf16 v[194:209], v[14:17], v[158:161], v[194:209]
    ds_read_b64 v[226:227], v226
    ds_read_b64 v[228:229], v228
    ds_read_b64 v[230:231], v230
    ds_read_b64 v[232:233], v232
    buffer_load_dwordx4 v[238:241], v1, s[12:15], s28 offen offset:1024 sc1
    s_waitcnt lgkmcnt(4)
    v_smfmac_f32_16x16x64_bf16 v[74:77], v[250:253], v[218:225], v254
    s_waitcnt vmcnt(3)
    v_lshlrev_b32_sdwa v218, 3, v242 dst_sel:DWORD dst_unused:UNUSED_PAD src0_sel:DWORD src1_sel:WORD_0
    v_lshlrev_b32_sdwa v220, 3, v242 dst_sel:DWORD dst_unused:UNUSED_PAD src0_sel:DWORD src1_sel:WORD_1
    v_lshlrev_b32_sdwa v222, 3, v243 dst_sel:DWORD dst_unused:UNUSED_PAD src0_sel:DWORD src1_sel:WORD_0
    v_lshlrev_b32_sdwa v224, 3, v243 dst_sel:DWORD dst_unused:UNUSED_PAD src0_sel:DWORD src1_sel:WORD_1
    ds_read_b64 v[218:219], v218
    ds_read_b64 v[220:221], v220
    ds_read_b64 v[222:223], v222
    ds_read_b64 v[224:225], v224
    s_waitcnt lgkmcnt(4)
    v_smfmac_f32_16x16x64_bf16 v[74:77], v[250:253], v[226:233], v254
    v_lshlrev_b32_sdwa v226, 3, v244 dst_sel:DWORD dst_unused:UNUSED_PAD src0_sel:DWORD src1_sel:WORD_0
    v_lshlrev_b32_sdwa v228, 3, v244 dst_sel:DWORD dst_unused:UNUSED_PAD src0_sel:DWORD src1_sel:WORD_1
    v_lshlrev_b32_sdwa v230, 3, v245 dst_sel:DWORD dst_unused:UNUSED_PAD src0_sel:DWORD src1_sel:WORD_0
    v_lshlrev_b32_sdwa v232, 3, v245 dst_sel:DWORD dst_unused:UNUSED_PAD src0_sel:DWORD src1_sel:WORD_1
    v_cvt_pk_bf16_f32 v162, v178, v194
    v_cvt_pk_bf16_f32 v163, v179, v195
    v_cvt_pk_bf16_f32 v164, v180, v196
    v_cvt_pk_bf16_f32 v165, v181, v197
    v_cvt_pk_bf16_f32 v166, v182, v198
    ds_read_b64 v[226:227], v226
    ds_read_b64 v[228:229], v228
    ds_read_b64 v[230:231], v230
    ds_read_b64 v[232:233], v232
    buffer_load_dwordx4 v[242:245], v1, s[12:15], s28 offen offset:2048 sc1
    s_waitcnt lgkmcnt(4)
    v_smfmac_f32_16x16x64_bf16 v[78:81], v[250:253], v[218:225], v254
    s_waitcnt vmcnt(3)
    v_lshlrev_b32_sdwa v218, 3, v246 dst_sel:DWORD dst_unused:UNUSED_PAD src0_sel:DWORD src1_sel:WORD_0
    v_lshlrev_b32_sdwa v220, 3, v246 dst_sel:DWORD dst_unused:UNUSED_PAD src0_sel:DWORD src1_sel:WORD_1
    v_lshlrev_b32_sdwa v222, 3, v247 dst_sel:DWORD dst_unused:UNUSED_PAD src0_sel:DWORD src1_sel:WORD_0
    v_lshlrev_b32_sdwa v224, 3, v247 dst_sel:DWORD dst_unused:UNUSED_PAD src0_sel:DWORD src1_sel:WORD_1
    v_cvt_pk_bf16_f32 v167, v183, v199
    v_cvt_pk_bf16_f32 v168, v184, v200
    v_cvt_pk_bf16_f32 v169, v185, v201
    v_cvt_pk_bf16_f32 v170, v186, v202
    v_cvt_pk_bf16_f32 v171, v187, v203
    ds_read_b64 v[218:219], v218
    ds_read_b64 v[220:221], v220
    ds_read_b64 v[222:223], v222
    ds_read_b64 v[224:225], v224
    s_waitcnt lgkmcnt(4)
    v_smfmac_f32_16x16x64_bf16 v[78:81], v[250:253], v[226:233], v254
    v_lshlrev_b32_sdwa v226, 3, v248 dst_sel:DWORD dst_unused:UNUSED_PAD src0_sel:DWORD src1_sel:WORD_0
    v_lshlrev_b32_sdwa v228, 3, v248 dst_sel:DWORD dst_unused:UNUSED_PAD src0_sel:DWORD src1_sel:WORD_1
    v_lshlrev_b32_sdwa v230, 3, v249 dst_sel:DWORD dst_unused:UNUSED_PAD src0_sel:DWORD src1_sel:WORD_0
    v_lshlrev_b32_sdwa v232, 3, v249 dst_sel:DWORD dst_unused:UNUSED_PAD src0_sel:DWORD src1_sel:WORD_1
    v_cvt_pk_bf16_f32 v172, v188, v204
    v_cvt_pk_bf16_f32 v173, v189, v205
    v_cvt_pk_bf16_f32 v174, v190, v206
    v_cvt_pk_bf16_f32 v175, v191, v207
    v_cvt_pk_bf16_f32 v176, v192, v208
    ds_read_b64 v[226:227], v226
    ds_read_b64 v[228:229], v228
    ds_read_b64 v[230:231], v230
    ds_read_b64 v[232:233], v232
    buffer_load_dwordx4 v[246:249], v1, s[12:15], s28 offen offset:3072 sc1
    s_add_u32 s28, s28, 4096
    s_waitcnt lgkmcnt(4)
    v_smfmac_f32_16x16x64_bf16 v[78:81], v[250:253], v[218:225], v254
    s_waitcnt vmcnt(3)
    v_lshlrev_b32_sdwa v218, 3, v234 dst_sel:DWORD dst_unused:UNUSED_PAD src0_sel:DWORD src1_sel:WORD_0
    v_lshlrev_b32_sdwa v220, 3, v234 dst_sel:DWORD dst_unused:UNUSED_PAD src0_sel:DWORD src1_sel:WORD_1
    v_lshlrev_b32_sdwa v222, 3, v235 dst_sel:DWORD dst_unused:UNUSED_PAD src0_sel:DWORD src1_sel:WORD_0
    v_lshlrev_b32_sdwa v224, 3, v235 dst_sel:DWORD dst_unused:UNUSED_PAD src0_sel:DWORD src1_sel:WORD_1
    v_cvt_pk_bf16_f32 v177, v193, v209
    v_mfma_f32_32x32x16_bf16 v[178:193], v[18:21], v[130:133], 0
    ds_read_b64 v[218:219], v218
    ds_read_b64 v[220:221], v220
    ds_read_b64 v[222:223], v222
    ds_read_b64 v[224:225], v224
    s_waitcnt lgkmcnt(4)
    v_smfmac_f32_16x16x64_bf16 v[78:81], v[250:253], v[226:233], v254
    v_lshlrev_b32_sdwa v226, 3, v236 dst_sel:DWORD dst_unused:UNUSED_PAD src0_sel:DWORD src1_sel:WORD_0
    v_lshlrev_b32_sdwa v228, 3, v236 dst_sel:DWORD dst_unused:UNUSED_PAD src0_sel:DWORD src1_sel:WORD_1
    v_lshlrev_b32_sdwa v230, 3, v237 dst_sel:DWORD dst_unused:UNUSED_PAD src0_sel:DWORD src1_sel:WORD_0
    v_lshlrev_b32_sdwa v232, 3, v237 dst_sel:DWORD dst_unused:UNUSED_PAD src0_sel:DWORD src1_sel:WORD_1
    v_mfma_f32_32x32x16_bf16 v[194:209], v[18:21], v[146:149], 0
    ds_read_b64 v[226:227], v226
    ds_read_b64 v[228:229], v228
    ds_read_b64 v[230:231], v230
    ds_read_b64 v[232:233], v232
    buffer_load_dwordx4 v[234:237], v1, s[12:15], s28 offen offset:0 sc1
    s_setprio 2
    s_waitcnt lgkmcnt(4)
    v_smfmac_f32_16x16x64_bf16 v[82:85], v[250:253], v[218:225], v254
    s_waitcnt vmcnt(3)
    v_lshlrev_b32_sdwa v218, 3, v238 dst_sel:DWORD dst_unused:UNUSED_PAD src0_sel:DWORD src1_sel:WORD_0
    v_lshlrev_b32_sdwa v220, 3, v238 dst_sel:DWORD dst_unused:UNUSED_PAD src0_sel:DWORD src1_sel:WORD_1
    v_lshlrev_b32_sdwa v222, 3, v239 dst_sel:DWORD dst_unused:UNUSED_PAD src0_sel:DWORD src1_sel:WORD_0
    v_lshlrev_b32_sdwa v224, 3, v239 dst_sel:DWORD dst_unused:UNUSED_PAD src0_sel:DWORD src1_sel:WORD_1
    v_mfma_f32_32x32x16_bf16 v[178:193], v[22:25], v[134:137], v[178:193]
    ds_read_b64 v[218:219], v218
    ds_read_b64 v[220:221], v220
    ds_read_b64 v[222:223], v222
    ds_read_b64 v[224:225], v224
    s_waitcnt lgkmcnt(4)
    v_smfmac_f32_16x16x64_bf16 v[82:85], v[250:253], v[226:233], v254
    v_lshlrev_b32_sdwa v226, 3, v240 dst_sel:DWORD dst_unused:UNUSED_PAD src0_sel:DWORD src1_sel:WORD_0
    v_lshlrev_b32_sdwa v228, 3, v240 dst_sel:DWORD dst_unused:UNUSED_PAD src0_sel:DWORD src1_sel:WORD_1
    v_lshlrev_b32_sdwa v230, 3, v241 dst_sel:DWORD dst_unused:UNUSED_PAD src0_sel:DWORD src1_sel:WORD_0
    v_lshlrev_b32_sdwa v232, 3, v241 dst_sel:DWORD dst_unused:UNUSED_PAD src0_sel:DWORD src1_sel:WORD_1
    v_mfma_f32_32x32x16_bf16 v[194:209], v[22:25], v[150:153], v[194:209]
    ds_read_b64 v[226:227], v226
    ds_read_b64 v[228:229], v228
    ds_read_b64 v[230:231], v230
    ds_read_b64 v[232:233], v232
    buffer_load_dwordx4 v[238:241], v1, s[12:15], s28 offen offset:1024 sc1
    s_waitcnt lgkmcnt(4)
    v_smfmac_f32_16x16x64_bf16 v[82:85], v[250:253], v[218:225], v254
    s_waitcnt vmcnt(3)
    v_lshlrev_b32_sdwa v218, 3, v242 dst_sel:DWORD dst_unused:UNUSED_PAD src0_sel:DWORD src1_sel:WORD_0
    v_lshlrev_b32_sdwa v220, 3, v242 dst_sel:DWORD dst_unused:UNUSED_PAD src0_sel:DWORD src1_sel:WORD_1
    v_lshlrev_b32_sdwa v222, 3, v243 dst_sel:DWORD dst_unused:UNUSED_PAD src0_sel:DWORD src1_sel:WORD_0
    v_lshlrev_b32_sdwa v224, 3, v243 dst_sel:DWORD dst_unused:UNUSED_PAD src0_sel:DWORD src1_sel:WORD_1
    v_mfma_f32_32x32x16_bf16 v[178:193], v[26:29], v[138:141], v[178:193]
    ds_read_b64 v[218:219], v218
    ds_read_b64 v[220:221], v220
    ds_read_b64 v[222:223], v222
    ds_read_b64 v[224:225], v224
    s_waitcnt lgkmcnt(4)
    v_smfmac_f32_16x16x64_bf16 v[82:85], v[250:253], v[226:233], v254
    v_lshlrev_b32_sdwa v226, 3, v244 dst_sel:DWORD dst_unused:UNUSED_PAD src0_sel:DWORD src1_sel:WORD_0
    v_lshlrev_b32_sdwa v228, 3, v244 dst_sel:DWORD dst_unused:UNUSED_PAD src0_sel:DWORD src1_sel:WORD_1
    v_lshlrev_b32_sdwa v230, 3, v245 dst_sel:DWORD dst_unused:UNUSED_PAD src0_sel:DWORD src1_sel:WORD_0
    v_lshlrev_b32_sdwa v232, 3, v245 dst_sel:DWORD dst_unused:UNUSED_PAD src0_sel:DWORD src1_sel:WORD_1
    v_mfma_f32_32x32x16_bf16 v[194:209], v[26:29], v[154:157], v[194:209]
    ds_read_b64 v[226:227], v226
    ds_read_b64 v[228:229], v228
    ds_read_b64 v[230:231], v230
    ds_read_b64 v[232:233], v232
    buffer_load_dwordx4 v[242:245], v1, s[12:15], s28 offen offset:2048 sc1
    s_waitcnt lgkmcnt(4)
    v_smfmac_f32_16x16x64_bf16 v[86:89], v[250:253], v[218:225], v254
    s_waitcnt vmcnt(3)
    v_lshlrev_b32_sdwa v218, 3, v246 dst_sel:DWORD dst_unused:UNUSED_PAD src0_sel:DWORD src1_sel:WORD_0
    v_lshlrev_b32_sdwa v220, 3, v246 dst_sel:DWORD dst_unused:UNUSED_PAD src0_sel:DWORD src1_sel:WORD_1
    v_lshlrev_b32_sdwa v222, 3, v247 dst_sel:DWORD dst_unused:UNUSED_PAD src0_sel:DWORD src1_sel:WORD_0
    v_lshlrev_b32_sdwa v224, 3, v247 dst_sel:DWORD dst_unused:UNUSED_PAD src0_sel:DWORD src1_sel:WORD_1
    v_mfma_f32_32x32x16_bf16 v[178:193], v[30:33], v[142:145], v[178:193]
    ds_read_b64 v[218:219], v218
    ds_read_b64 v[220:221], v220
    ds_read_b64 v[222:223], v222
    ds_read_b64 v[224:225], v224
    s_waitcnt lgkmcnt(4)
    v_smfmac_f32_16x16x64_bf16 v[86:89], v[250:253], v[226:233], v254
    v_lshlrev_b32_sdwa v226, 3, v248 dst_sel:DWORD dst_unused:UNUSED_PAD src0_sel:DWORD src1_sel:WORD_0
    v_lshlrev_b32_sdwa v228, 3, v248 dst_sel:DWORD dst_unused:UNUSED_PAD src0_sel:DWORD src1_sel:WORD_1
    v_lshlrev_b32_sdwa v230, 3, v249 dst_sel:DWORD dst_unused:UNUSED_PAD src0_sel:DWORD src1_sel:WORD_0
    v_lshlrev_b32_sdwa v232, 3, v249 dst_sel:DWORD dst_unused:UNUSED_PAD src0_sel:DWORD src1_sel:WORD_1
    v_mfma_f32_32x32x16_bf16 v[194:209], v[30:33], v[158:161], v[194:209]
    ds_read_b64 v[226:227], v226
    ds_read_b64 v[228:229], v228
    ds_read_b64 v[230:231], v230
    ds_read_b64 v[232:233], v232
    buffer_load_dwordx4 v[246:249], v1, s[12:15], s28 offen offset:3072 sc1
    s_add_u32 s28, s28, 4096
    s_add_u32 s28, s28, s46
    s_waitcnt lgkmcnt(4)
    v_smfmac_f32_16x16x64_bf16 v[86:89], v[250:253], v[218:225], v254
    s_waitcnt vmcnt(3)
    v_lshlrev_b32_sdwa v218, 3, v234 dst_sel:DWORD dst_unused:UNUSED_PAD src0_sel:DWORD src1_sel:WORD_0
    v_lshlrev_b32_sdwa v220, 3, v234 dst_sel:DWORD dst_unused:UNUSED_PAD src0_sel:DWORD src1_sel:WORD_1
    v_lshlrev_b32_sdwa v222, 3, v235 dst_sel:DWORD dst_unused:UNUSED_PAD src0_sel:DWORD src1_sel:WORD_0
    v_lshlrev_b32_sdwa v224, 3, v235 dst_sel:DWORD dst_unused:UNUSED_PAD src0_sel:DWORD src1_sel:WORD_1
    ds_read_b64 v[218:219], v218
    ds_read_b64 v[220:221], v220
    ds_read_b64 v[222:223], v222
    ds_read_b64 v[224:225], v224
    s_waitcnt lgkmcnt(4)
    v_smfmac_f32_16x16x64_bf16 v[86:89], v[250:253], v[226:233], v254
    v_lshlrev_b32_sdwa v226, 3, v236 dst_sel:DWORD dst_unused:UNUSED_PAD src0_sel:DWORD src1_sel:WORD_0
    v_lshlrev_b32_sdwa v228, 3, v236 dst_sel:DWORD dst_unused:UNUSED_PAD src0_sel:DWORD src1_sel:WORD_1
    v_lshlrev_b32_sdwa v230, 3, v237 dst_sel:DWORD dst_unused:UNUSED_PAD src0_sel:DWORD src1_sel:WORD_0
    v_lshlrev_b32_sdwa v232, 3, v237 dst_sel:DWORD dst_unused:UNUSED_PAD src0_sel:DWORD src1_sel:WORD_1
    v_cvt_pk_bf16_f32 v178, v178, v194
    v_cvt_pk_bf16_f32 v179, v179, v195
    v_cvt_pk_bf16_f32 v180, v180, v196
    v_cvt_pk_bf16_f32 v181, v181, v197
    v_cvt_pk_bf16_f32 v182, v182, v198
    ds_read_b64 v[226:227], v226
    ds_read_b64 v[228:229], v228
    ds_read_b64 v[230:231], v230
    ds_read_b64 v[232:233], v232
    buffer_load_dwordx4 v[234:237], v1, s[12:15], s28 offen offset:0 sc1
    s_waitcnt lgkmcnt(4)
    v_smfmac_f32_16x16x64_bf16 v[90:93], v[250:253], v[218:225], v254
    s_waitcnt vmcnt(3)
    v_lshlrev_b32_sdwa v218, 3, v238 dst_sel:DWORD dst_unused:UNUSED_PAD src0_sel:DWORD src1_sel:WORD_0
    v_lshlrev_b32_sdwa v220, 3, v238 dst_sel:DWORD dst_unused:UNUSED_PAD src0_sel:DWORD src1_sel:WORD_1
    v_lshlrev_b32_sdwa v222, 3, v239 dst_sel:DWORD dst_unused:UNUSED_PAD src0_sel:DWORD src1_sel:WORD_0
    v_lshlrev_b32_sdwa v224, 3, v239 dst_sel:DWORD dst_unused:UNUSED_PAD src0_sel:DWORD src1_sel:WORD_1
    v_cvt_pk_bf16_f32 v183, v183, v199
    v_cvt_pk_bf16_f32 v184, v184, v200
    v_cvt_pk_bf16_f32 v185, v185, v201
    v_cvt_pk_bf16_f32 v186, v186, v202
    v_cvt_pk_bf16_f32 v187, v187, v203
    ds_read_b64 v[218:219], v218
    ds_read_b64 v[220:221], v220
    ds_read_b64 v[222:223], v222
    ds_read_b64 v[224:225], v224
    s_waitcnt lgkmcnt(4)
    v_smfmac_f32_16x16x64_bf16 v[90:93], v[250:253], v[226:233], v254
    v_lshlrev_b32_sdwa v226, 3, v240 dst_sel:DWORD dst_unused:UNUSED_PAD src0_sel:DWORD src1_sel:WORD_0
    v_lshlrev_b32_sdwa v228, 3, v240 dst_sel:DWORD dst_unused:UNUSED_PAD src0_sel:DWORD src1_sel:WORD_1
    v_lshlrev_b32_sdwa v230, 3, v241 dst_sel:DWORD dst_unused:UNUSED_PAD src0_sel:DWORD src1_sel:WORD_0
    v_lshlrev_b32_sdwa v232, 3, v241 dst_sel:DWORD dst_unused:UNUSED_PAD src0_sel:DWORD src1_sel:WORD_1
    v_cvt_pk_bf16_f32 v188, v188, v204
    v_cvt_pk_bf16_f32 v189, v189, v205
    v_cvt_pk_bf16_f32 v190, v190, v206
    v_cvt_pk_bf16_f32 v191, v191, v207
    v_cvt_pk_bf16_f32 v192, v192, v208
    ds_read_b64 v[226:227], v226
    ds_read_b64 v[228:229], v228
    ds_read_b64 v[230:231], v230
    ds_read_b64 v[232:233], v232
    buffer_load_dwordx4 v[238:241], v1, s[12:15], s28 offen offset:1024 sc1
    s_waitcnt lgkmcnt(4)
    v_smfmac_f32_16x16x64_bf16 v[90:93], v[250:253], v[218:225], v254
    s_waitcnt vmcnt(3)
    v_lshlrev_b32_sdwa v218, 3, v242 dst_sel:DWORD dst_unused:UNUSED_PAD src0_sel:DWORD src1_sel:WORD_0
    v_lshlrev_b32_sdwa v220, 3, v242 dst_sel:DWORD dst_unused:UNUSED_PAD src0_sel:DWORD src1_sel:WORD_1
    v_lshlrev_b32_sdwa v222, 3, v243 dst_sel:DWORD dst_unused:UNUSED_PAD src0_sel:DWORD src1_sel:WORD_0
    v_lshlrev_b32_sdwa v224, 3, v243 dst_sel:DWORD dst_unused:UNUSED_PAD src0_sel:DWORD src1_sel:WORD_1
    v_cvt_pk_bf16_f32 v193, v193, v209
    v_mfma_f32_32x32x16_bf16 v[194:209], v[34:37], v[130:133], 0
    ds_read_b64 v[218:219], v218
    ds_read_b64 v[220:221], v220
    ds_read_b64 v[222:223], v222
    ds_read_b64 v[224:225], v224
    s_waitcnt lgkmcnt(4)
    v_smfmac_f32_16x16x64_bf16 v[90:93], v[250:253], v[226:233], v254
    v_lshlrev_b32_sdwa v226, 3, v244 dst_sel:DWORD dst_unused:UNUSED_PAD src0_sel:DWORD src1_sel:WORD_0
    v_lshlrev_b32_sdwa v228, 3, v244 dst_sel:DWORD dst_unused:UNUSED_PAD src0_sel:DWORD src1_sel:WORD_1
    v_lshlrev_b32_sdwa v230, 3, v245 dst_sel:DWORD dst_unused:UNUSED_PAD src0_sel:DWORD src1_sel:WORD_0
    v_lshlrev_b32_sdwa v232, 3, v245 dst_sel:DWORD dst_unused:UNUSED_PAD src0_sel:DWORD src1_sel:WORD_1
    v_mfma_f32_32x32x16_bf16 v[194:209], v[38:41], v[134:137], v[194:209]
    ds_read_b64 v[226:227], v226
    ds_read_b64 v[228:229], v228
    ds_read_b64 v[230:231], v230
    ds_read_b64 v[232:233], v232
    buffer_load_dwordx4 v[242:245], v1, s[12:15], s28 offen offset:2048 sc1
    s_waitcnt lgkmcnt(4)
    v_smfmac_f32_16x16x64_bf16 v[94:97], v[250:253], v[218:225], v254
    s_waitcnt vmcnt(3)
    v_lshlrev_b32_sdwa v218, 3, v246 dst_sel:DWORD dst_unused:UNUSED_PAD src0_sel:DWORD src1_sel:WORD_0
    v_lshlrev_b32_sdwa v220, 3, v246 dst_sel:DWORD dst_unused:UNUSED_PAD src0_sel:DWORD src1_sel:WORD_1
    v_lshlrev_b32_sdwa v222, 3, v247 dst_sel:DWORD dst_unused:UNUSED_PAD src0_sel:DWORD src1_sel:WORD_0
    v_lshlrev_b32_sdwa v224, 3, v247 dst_sel:DWORD dst_unused:UNUSED_PAD src0_sel:DWORD src1_sel:WORD_1
    v_mfma_f32_32x32x16_bf16 v[194:209], v[42:45], v[138:141], v[194:209]
    ds_read_b64 v[218:219], v218
    ds_read_b64 v[220:221], v220
    ds_read_b64 v[222:223], v222
    ds_read_b64 v[224:225], v224
    s_waitcnt lgkmcnt(4)
    v_smfmac_f32_16x16x64_bf16 v[94:97], v[250:253], v[226:233], v254
    v_lshlrev_b32_sdwa v226, 3, v248 dst_sel:DWORD dst_unused:UNUSED_PAD src0_sel:DWORD src1_sel:WORD_0
    v_lshlrev_b32_sdwa v228, 3, v248 dst_sel:DWORD dst_unused:UNUSED_PAD src0_sel:DWORD src1_sel:WORD_1
    v_lshlrev_b32_sdwa v230, 3, v249 dst_sel:DWORD dst_unused:UNUSED_PAD src0_sel:DWORD src1_sel:WORD_0
    v_lshlrev_b32_sdwa v232, 3, v249 dst_sel:DWORD dst_unused:UNUSED_PAD src0_sel:DWORD src1_sel:WORD_1
    v_mfma_f32_32x32x16_bf16 v[194:209], v[46:49], v[142:145], v[194:209]
    ds_read_b64 v[226:227], v226
    ds_read_b64 v[228:229], v228
    ds_read_b64 v[230:231], v230
    ds_read_b64 v[232:233], v232
    buffer_load_dwordx4 v[246:249], v1, s[12:15], s28 offen offset:3072 sc1
    s_add_u32 s28, s28, 4096
    s_waitcnt lgkmcnt(4)
    v_smfmac_f32_16x16x64_bf16 v[94:97], v[250:253], v[218:225], v254
    s_waitcnt vmcnt(3)
    v_lshlrev_b32_sdwa v218, 3, v234 dst_sel:DWORD dst_unused:UNUSED_PAD src0_sel:DWORD src1_sel:WORD_0
    v_lshlrev_b32_sdwa v220, 3, v234 dst_sel:DWORD dst_unused:UNUSED_PAD src0_sel:DWORD src1_sel:WORD_1
    v_lshlrev_b32_sdwa v222, 3, v235 dst_sel:DWORD dst_unused:UNUSED_PAD src0_sel:DWORD src1_sel:WORD_0
    v_lshlrev_b32_sdwa v224, 3, v235 dst_sel:DWORD dst_unused:UNUSED_PAD src0_sel:DWORD src1_sel:WORD_1
    ds_read_b64 v[218:219], v218
    ds_read_b64 v[220:221], v220
    ds_read_b64 v[222:223], v222
    ds_read_b64 v[224:225], v224
    s_waitcnt lgkmcnt(4)
    v_smfmac_f32_16x16x64_bf16 v[94:97], v[250:253], v[226:233], v254
    v_lshlrev_b32_sdwa v226, 3, v236 dst_sel:DWORD dst_unused:UNUSED_PAD src0_sel:DWORD src1_sel:WORD_0
    v_lshlrev_b32_sdwa v228, 3, v236 dst_sel:DWORD dst_unused:UNUSED_PAD src0_sel:DWORD src1_sel:WORD_1
    v_lshlrev_b32_sdwa v230, 3, v237 dst_sel:DWORD dst_unused:UNUSED_PAD src0_sel:DWORD src1_sel:WORD_0
    v_lshlrev_b32_sdwa v232, 3, v237 dst_sel:DWORD dst_unused:UNUSED_PAD src0_sel:DWORD src1_sel:WORD_1
    v_cvt_pk_bf16_f32 v210, v194, v195
    v_cvt_pk_bf16_f32 v211, v196, v197
    v_cvt_pk_bf16_f32 v212, v198, v199
    v_cvt_pk_bf16_f32 v213, v200, v201
    v_cvt_pk_bf16_f32 v214, v202, v203
    ds_read_b64 v[226:227], v226
    ds_read_b64 v[228:229], v228
    ds_read_b64 v[230:231], v230
    ds_read_b64 v[232:233], v232
    buffer_load_dwordx4 v[234:237], v1, s[12:15], s28 offen offset:0 sc1
    s_setprio 1
    s_waitcnt lgkmcnt(4)
    v_smfmac_f32_16x16x64_bf16 v[98:101], v[250:253], v[218:225], v254
    s_waitcnt vmcnt(3)
    v_lshlrev_b32_sdwa v218, 3, v238 dst_sel:DWORD dst_unused:UNUSED_PAD src0_sel:DWORD src1_sel:WORD_0
    v_lshlrev_b32_sdwa v220, 3, v238 dst_sel:DWORD dst_unused:UNUSED_PAD src0_sel:DWORD src1_sel:WORD_1
    v_lshlrev_b32_sdwa v222, 3, v239 dst_sel:DWORD dst_unused:UNUSED_PAD src0_sel:DWORD src1_sel:WORD_0
    v_lshlrev_b32_sdwa v224, 3, v239 dst_sel:DWORD dst_unused:UNUSED_PAD src0_sel:DWORD src1_sel:WORD_1
    v_cvt_pk_bf16_f32 v215, v204, v205
    v_cvt_pk_bf16_f32 v216, v206, v207
    v_cvt_pk_bf16_f32 v217, v208, v209
    v_mfma_f32_32x32x16_bf16 v[194:209], v[50:53], v[130:133], 0
    ds_read_b64 v[218:219], v218
    ds_read_b64 v[220:221], v220
    ds_read_b64 v[222:223], v222
    ds_read_b64 v[224:225], v224
    s_waitcnt lgkmcnt(4)
    v_smfmac_f32_16x16x64_bf16 v[98:101], v[250:253], v[226:233], v254
    v_lshlrev_b32_sdwa v226, 3, v240 dst_sel:DWORD dst_unused:UNUSED_PAD src0_sel:DWORD src1_sel:WORD_0
    v_lshlrev_b32_sdwa v228, 3, v240 dst_sel:DWORD dst_unused:UNUSED_PAD src0_sel:DWORD src1_sel:WORD_1
    v_lshlrev_b32_sdwa v230, 3, v241 dst_sel:DWORD dst_unused:UNUSED_PAD src0_sel:DWORD src1_sel:WORD_0
    v_lshlrev_b32_sdwa v232, 3, v241 dst_sel:DWORD dst_unused:UNUSED_PAD src0_sel:DWORD src1_sel:WORD_1
    v_mfma_f32_32x32x16_bf16 v[194:209], v[54:57], v[134:137], v[194:209]
    ds_read_b64 v[226:227], v226
    ds_read_b64 v[228:229], v228
    ds_read_b64 v[230:231], v230
    ds_read_b64 v[232:233], v232
    buffer_load_dwordx4 v[238:241], v1, s[12:15], s28 offen offset:1024 sc1
    s_waitcnt lgkmcnt(4)
    v_smfmac_f32_16x16x64_bf16 v[98:101], v[250:253], v[218:225], v254
    s_waitcnt vmcnt(3)
    v_lshlrev_b32_sdwa v218, 3, v242 dst_sel:DWORD dst_unused:UNUSED_PAD src0_sel:DWORD src1_sel:WORD_0
    v_lshlrev_b32_sdwa v220, 3, v242 dst_sel:DWORD dst_unused:UNUSED_PAD src0_sel:DWORD src1_sel:WORD_1
    v_lshlrev_b32_sdwa v222, 3, v243 dst_sel:DWORD dst_unused:UNUSED_PAD src0_sel:DWORD src1_sel:WORD_0
    v_lshlrev_b32_sdwa v224, 3, v243 dst_sel:DWORD dst_unused:UNUSED_PAD src0_sel:DWORD src1_sel:WORD_1
    v_mfma_f32_32x32x16_bf16 v[194:209], v[58:61], v[138:141], v[194:209]
    ds_read_b64 v[218:219], v218
    ds_read_b64 v[220:221], v220
    ds_read_b64 v[222:223], v222
    ds_read_b64 v[224:225], v224
    s_waitcnt lgkmcnt(4)
    v_smfmac_f32_16x16x64_bf16 v[98:101], v[250:253], v[226:233], v254
    v_lshlrev_b32_sdwa v226, 3, v244 dst_sel:DWORD dst_unused:UNUSED_PAD src0_sel:DWORD src1_sel:WORD_0
    v_lshlrev_b32_sdwa v228, 3, v244 dst_sel:DWORD dst_unused:UNUSED_PAD src0_sel:DWORD src1_sel:WORD_1
    v_lshlrev_b32_sdwa v230, 3, v245 dst_sel:DWORD dst_unused:UNUSED_PAD src0_sel:DWORD src1_sel:WORD_0
    v_lshlrev_b32_sdwa v232, 3, v245 dst_sel:DWORD dst_unused:UNUSED_PAD src0_sel:DWORD src1_sel:WORD_1
    v_mfma_f32_32x32x16_bf16 v[194:209], v[62:65], v[142:145], v[194:209]
    ds_read_b64 v[226:227], v226
    ds_read_b64 v[228:229], v228
    ds_read_b64 v[230:231], v230
    ds_read_b64 v[232:233], v232
    buffer_load_dwordx4 v[242:245], v1, s[12:15], s28 offen offset:2048 sc1
    s_waitcnt lgkmcnt(4)
    v_smfmac_f32_16x16x64_bf16 v[102:105], v[250:253], v[218:225], v254
    s_waitcnt vmcnt(3)
    v_lshlrev_b32_sdwa v218, 3, v246 dst_sel:DWORD dst_unused:UNUSED_PAD src0_sel:DWORD src1_sel:WORD_0
    v_lshlrev_b32_sdwa v220, 3, v246 dst_sel:DWORD dst_unused:UNUSED_PAD src0_sel:DWORD src1_sel:WORD_1
    v_lshlrev_b32_sdwa v222, 3, v247 dst_sel:DWORD dst_unused:UNUSED_PAD src0_sel:DWORD src1_sel:WORD_0
    v_lshlrev_b32_sdwa v224, 3, v247 dst_sel:DWORD dst_unused:UNUSED_PAD src0_sel:DWORD src1_sel:WORD_1
    v_mfma_f32_32x32x16_bf16 v[130:145], v[34:37], v[146:149], 0
    ds_read_b64 v[218:219], v218
    ds_read_b64 v[220:221], v220
    ds_read_b64 v[222:223], v222
    ds_read_b64 v[224:225], v224
    s_waitcnt lgkmcnt(4)
    v_smfmac_f32_16x16x64_bf16 v[102:105], v[250:253], v[226:233], v254
    v_lshlrev_b32_sdwa v226, 3, v248 dst_sel:DWORD dst_unused:UNUSED_PAD src0_sel:DWORD src1_sel:WORD_0
    v_lshlrev_b32_sdwa v228, 3, v248 dst_sel:DWORD dst_unused:UNUSED_PAD src0_sel:DWORD src1_sel:WORD_1
    v_lshlrev_b32_sdwa v230, 3, v249 dst_sel:DWORD dst_unused:UNUSED_PAD src0_sel:DWORD src1_sel:WORD_0
    v_lshlrev_b32_sdwa v232, 3, v249 dst_sel:DWORD dst_unused:UNUSED_PAD src0_sel:DWORD src1_sel:WORD_1
    v_cvt_pk_bf16_f32 v194, v194, v195
    v_cvt_pk_bf16_f32 v195, v196, v197
    v_cvt_pk_bf16_f32 v196, v198, v199
    v_cvt_pk_bf16_f32 v197, v200, v201
    v_cvt_pk_bf16_f32 v198, v202, v203
    v_mfma_f32_32x32x16_bf16 v[130:145], v[38:41], v[150:153], v[130:145]
    ds_read_b64 v[226:227], v226
    ds_read_b64 v[228:229], v228
    ds_read_b64 v[230:231], v230
    ds_read_b64 v[232:233], v232
    buffer_load_dwordx4 v[246:249], v1, s[12:15], s28 offen offset:3072 sc1
    s_add_u32 s28, s28, 4096
    s_waitcnt lgkmcnt(4)
    v_smfmac_f32_16x16x64_bf16 v[102:105], v[250:253], v[218:225], v254
    s_waitcnt vmcnt(3)
    v_lshlrev_b32_sdwa v218, 3, v234 dst_sel:DWORD dst_unused:UNUSED_PAD src0_sel:DWORD src1_sel:WORD_0
    v_lshlrev_b32_sdwa v220, 3, v234 dst_sel:DWORD dst_unused:UNUSED_PAD src0_sel:DWORD src1_sel:WORD_1
    v_lshlrev_b32_sdwa v222, 3, v235 dst_sel:DWORD dst_unused:UNUSED_PAD src0_sel:DWORD src1_sel:WORD_0
    v_lshlrev_b32_sdwa v224, 3, v235 dst_sel:DWORD dst_unused:UNUSED_PAD src0_sel:DWORD src1_sel:WORD_1
    v_cvt_pk_bf16_f32 v199, v204, v205
    v_cvt_pk_bf16_f32 v200, v206, v207
    v_cvt_pk_bf16_f32 v201, v208, v209
    v_mfma_f32_32x32x16_bf16 v[130:145], v[42:45], v[154:157], v[130:145]
    ds_read_b64 v[218:219], v218
    ds_read_b64 v[220:221], v220
    ds_read_b64 v[222:223], v222
    ds_read_b64 v[224:225], v224
    s_waitcnt lgkmcnt(4)
    v_smfmac_f32_16x16x64_bf16 v[102:105], v[250:253], v[226:233], v254
    v_lshlrev_b32_sdwa v226, 3, v236 dst_sel:DWORD dst_unused:UNUSED_PAD src0_sel:DWORD src1_sel:WORD_0
    v_lshlrev_b32_sdwa v228, 3, v236 dst_sel:DWORD dst_unused:UNUSED_PAD src0_sel:DWORD src1_sel:WORD_1
    v_lshlrev_b32_sdwa v230, 3, v237 dst_sel:DWORD dst_unused:UNUSED_PAD src0_sel:DWORD src1_sel:WORD_0
    v_lshlrev_b32_sdwa v232, 3, v237 dst_sel:DWORD dst_unused:UNUSED_PAD src0_sel:DWORD src1_sel:WORD_1
    v_mfma_f32_32x32x16_bf16 v[130:145], v[46:49], v[158:161], v[130:145]
    ds_read_b64 v[226:227], v226
    ds_read_b64 v[228:229], v228
    ds_read_b64 v[230:231], v230
    ds_read_b64 v[232:233], v232
    buffer_load_dwordx4 v[234:237], v1, s[12:15], s28 offen offset:0 sc1
    s_waitcnt lgkmcnt(4)
    v_smfmac_f32_16x16x64_bf16 v[106:109], v[250:253], v[218:225], v254
    s_waitcnt vmcnt(3)
    v_lshlrev_b32_sdwa v218, 3, v238 dst_sel:DWORD dst_unused:UNUSED_PAD src0_sel:DWORD src1_sel:WORD_0
    v_lshlrev_b32_sdwa v220, 3, v238 dst_sel:DWORD dst_unused:UNUSED_PAD src0_sel:DWORD src1_sel:WORD_1
    v_lshlrev_b32_sdwa v222, 3, v239 dst_sel:DWORD dst_unused:UNUSED_PAD src0_sel:DWORD src1_sel:WORD_0
    v_lshlrev_b32_sdwa v224, 3, v239 dst_sel:DWORD dst_unused:UNUSED_PAD src0_sel:DWORD src1_sel:WORD_1
    ds_read_b64 v[218:219], v218
    ds_read_b64 v[220:221], v220
    ds_read_b64 v[222:223], v222
    ds_read_b64 v[224:225], v224
    s_waitcnt lgkmcnt(4)
    v_smfmac_f32_16x16x64_bf16 v[106:109], v[250:253], v[226:233], v254
    v_lshlrev_b32_sdwa v226, 3, v240 dst_sel:DWORD dst_unused:UNUSED_PAD src0_sel:DWORD src1_sel:WORD_0
    v_lshlrev_b32_sdwa v228, 3, v240 dst_sel:DWORD dst_unused:UNUSED_PAD src0_sel:DWORD src1_sel:WORD_1
    v_lshlrev_b32_sdwa v230, 3, v241 dst_sel:DWORD dst_unused:UNUSED_PAD src0_sel:DWORD src1_sel:WORD_0
    v_lshlrev_b32_sdwa v232, 3, v241 dst_sel:DWORD dst_unused:UNUSED_PAD src0_sel:DWORD src1_sel:WORD_1
    v_cvt_pk_bf16_f32 v130, v130, v131
    v_cvt_pk_bf16_f32 v131, v132, v133
    v_cvt_pk_bf16_f32 v132, v134, v135
    v_cvt_pk_bf16_f32 v133, v136, v137
    v_cvt_pk_bf16_f32 v134, v138, v139
    ds_read_b64 v[226:227], v226
    ds_read_b64 v[228:229], v228
    ds_read_b64 v[230:231], v230
    ds_read_b64 v[232:233], v232
    buffer_load_dwordx4 v[238:241], v1, s[12:15], s28 offen offset:1024 sc1
    s_waitcnt lgkmcnt(4)
    v_smfmac_f32_16x16x64_bf16 v[106:109], v[250:253], v[218:225], v254
    s_waitcnt vmcnt(3)
    v_lshlrev_b32_sdwa v218, 3, v242 dst_sel:DWORD dst_unused:UNUSED_PAD src0_sel:DWORD src1_sel:WORD_0
    v_lshlrev_b32_sdwa v220, 3, v242 dst_sel:DWORD dst_unused:UNUSED_PAD src0_sel:DWORD src1_sel:WORD_1
    v_lshlrev_b32_sdwa v222, 3, v243 dst_sel:DWORD dst_unused:UNUSED_PAD src0_sel:DWORD src1_sel:WORD_0
    v_lshlrev_b32_sdwa v224, 3, v243 dst_sel:DWORD dst_unused:UNUSED_PAD src0_sel:DWORD src1_sel:WORD_1
    v_cvt_pk_bf16_f32 v135, v140, v141
    v_cvt_pk_bf16_f32 v136, v142, v143
    v_cvt_pk_bf16_f32 v137, v144, v145
    v_perm_b32 v145, v137, v217, s67
    v_perm_b32 v144, v137, v217, s66
    ds_read_b64 v[218:219], v218
    ds_read_b64 v[220:221], v220
    ds_read_b64 v[222:223], v222
    ds_read_b64 v[224:225], v224
    s_waitcnt lgkmcnt(4)
    v_smfmac_f32_16x16x64_bf16 v[106:109], v[250:253], v[226:233], v254
    v_lshlrev_b32_sdwa v226, 3, v244 dst_sel:DWORD dst_unused:UNUSED_PAD src0_sel:DWORD src1_sel:WORD_0
    v_lshlrev_b32_sdwa v228, 3, v244 dst_sel:DWORD dst_unused:UNUSED_PAD src0_sel:DWORD src1_sel:WORD_1
    v_lshlrev_b32_sdwa v230, 3, v245 dst_sel:DWORD dst_unused:UNUSED_PAD src0_sel:DWORD src1_sel:WORD_0
    v_lshlrev_b32_sdwa v232, 3, v245 dst_sel:DWORD dst_unused:UNUSED_PAD src0_sel:DWORD src1_sel:WORD_1
    v_perm_b32 v143, v136, v216, s67
    v_perm_b32 v142, v136, v216, s66
    v_perm_b32 v141, v135, v215, s67
    v_perm_b32 v140, v135, v215, s66
    v_perm_b32 v139, v134, v214, s67
    ds_read_b64 v[226:227], v226
    ds_read_b64 v[228:229], v228
    ds_read_b64 v[230:231], v230
    ds_read_b64 v[232:233], v232
    buffer_load_dwordx4 v[242:245], v1, s[12:15], s28 offen offset:2048 sc1
    s_waitcnt lgkmcnt(4)
    v_smfmac_f32_16x16x64_bf16 v[110:113], v[250:253], v[218:225], v254
    s_waitcnt vmcnt(3)
    v_lshlrev_b32_sdwa v218, 3, v246 dst_sel:DWORD dst_unused:UNUSED_PAD src0_sel:DWORD src1_sel:WORD_0
    v_lshlrev_b32_sdwa v220, 3, v246 dst_sel:DWORD dst_unused:UNUSED_PAD src0_sel:DWORD src1_sel:WORD_1
    v_lshlrev_b32_sdwa v222, 3, v247 dst_sel:DWORD dst_unused:UNUSED_PAD src0_sel:DWORD src1_sel:WORD_0
    v_lshlrev_b32_sdwa v224, 3, v247 dst_sel:DWORD dst_unused:UNUSED_PAD src0_sel:DWORD src1_sel:WORD_1
    v_perm_b32 v138, v134, v214, s66
    v_perm_b32 v137, v133, v213, s67
    v_perm_b32 v136, v133, v213, s66
    v_perm_b32 v135, v132, v212, s67
    v_perm_b32 v134, v132, v212, s66
    ds_read_b64 v[218:219], v218
    ds_read_b64 v[220:221], v220
    ds_read_b64 v[222:223], v222
    ds_read_b64 v[224:225], v224
    s_waitcnt lgkmcnt(4)
    v_smfmac_f32_16x16x64_bf16 v[110:113], v[250:253], v[226:233], v254
    v_lshlrev_b32_sdwa v226, 3, v248 dst_sel:DWORD dst_unused:UNUSED_PAD src0_sel:DWORD src1_sel:WORD_0
    v_lshlrev_b32_sdwa v228, 3, v248 dst_sel:DWORD dst_unused:UNUSED_PAD src0_sel:DWORD src1_sel:WORD_1
    v_lshlrev_b32_sdwa v230, 3, v249 dst_sel:DWORD dst_unused:UNUSED_PAD src0_sel:DWORD src1_sel:WORD_0
    v_lshlrev_b32_sdwa v232, 3, v249 dst_sel:DWORD dst_unused:UNUSED_PAD src0_sel:DWORD src1_sel:WORD_1
    v_perm_b32 v133, v131, v211, s67
    v_perm_b32 v132, v131, v211, s66
    v_perm_b32 v131, v130, v210, s67
    v_perm_b32 v130, v130, v210, s66
    v_mov_b32 v210, v194
    ds_read_b64 v[226:227], v226
    ds_read_b64 v[228:229], v228
    ds_read_b64 v[230:231], v230
    ds_read_b64 v[232:233], v232
    buffer_load_dwordx4 v[246:249], v1, s[12:15], s28 offen offset:3072 sc1
    s_add_u32 s28, s28, 4096
    s_waitcnt lgkmcnt(4)
    v_smfmac_f32_16x16x64_bf16 v[110:113], v[250:253], v[218:225], v254
    s_waitcnt vmcnt(3)
    v_lshlrev_b32_sdwa v218, 3, v234 dst_sel:DWORD dst_unused:UNUSED_PAD src0_sel:DWORD src1_sel:WORD_0
    v_lshlrev_b32_sdwa v220, 3, v234 dst_sel:DWORD dst_unused:UNUSED_PAD src0_sel:DWORD src1_sel:WORD_1
    v_lshlrev_b32_sdwa v222, 3, v235 dst_sel:DWORD dst_unused:UNUSED_PAD src0_sel:DWORD src1_sel:WORD_0
    v_lshlrev_b32_sdwa v224, 3, v235 dst_sel:DWORD dst_unused:UNUSED_PAD src0_sel:DWORD src1_sel:WORD_1
    v_mov_b32 v211, v195
    v_mov_b32 v212, v196
    v_mov_b32 v213, v197
    v_mov_b32 v214, v198
    v_mov_b32 v215, v199
    ds_read_b64 v[218:219], v218
    ds_read_b64 v[220:221], v220
    ds_read_b64 v[222:223], v222
    ds_read_b64 v[224:225], v224
    s_waitcnt lgkmcnt(4)
    v_smfmac_f32_16x16x64_bf16 v[110:113], v[250:253], v[226:233], v254
    v_lshlrev_b32_sdwa v226, 3, v236 dst_sel:DWORD dst_unused:UNUSED_PAD src0_sel:DWORD src1_sel:WORD_0
    v_lshlrev_b32_sdwa v228, 3, v236 dst_sel:DWORD dst_unused:UNUSED_PAD src0_sel:DWORD src1_sel:WORD_1
    v_lshlrev_b32_sdwa v230, 3, v237 dst_sel:DWORD dst_unused:UNUSED_PAD src0_sel:DWORD src1_sel:WORD_0
    v_lshlrev_b32_sdwa v232, 3, v237 dst_sel:DWORD dst_unused:UNUSED_PAD src0_sel:DWORD src1_sel:WORD_1
    v_mov_b32 v216, v200
    v_mov_b32 v217, v201
    v_mfma_f32_32x32x16_bf16 v[194:209], v[50:53], v[146:149], 0
    ds_read_b64 v[226:227], v226
    ds_read_b64 v[228:229], v228
    ds_read_b64 v[230:231], v230
    ds_read_b64 v[232:233], v232
    buffer_load_dwordx4 v[234:237], v1, s[12:15], s28 offen offset:0 sc1
    s_setprio 0
    s_waitcnt lgkmcnt(4)
    v_smfmac_f32_16x16x64_bf16 v[114:117], v[250:253], v[218:225], v254
    s_waitcnt vmcnt(3)
    v_lshlrev_b32_sdwa v218, 3, v238 dst_sel:DWORD dst_unused:UNUSED_PAD src0_sel:DWORD src1_sel:WORD_0
    v_lshlrev_b32_sdwa v220, 3, v238 dst_sel:DWORD dst_unused:UNUSED_PAD src0_sel:DWORD src1_sel:WORD_1
    v_lshlrev_b32_sdwa v222, 3, v239 dst_sel:DWORD dst_unused:UNUSED_PAD src0_sel:DWORD src1_sel:WORD_0
    v_lshlrev_b32_sdwa v224, 3, v239 dst_sel:DWORD dst_unused:UNUSED_PAD src0_sel:DWORD src1_sel:WORD_1
    v_mfma_f32_32x32x16_bf16 v[194:209], v[54:57], v[150:153], v[194:209]
    ds_read_b64 v[218:219], v218
    ds_read_b64 v[220:221], v220
    ds_read_b64 v[222:223], v222
    ds_read_b64 v[224:225], v224
    s_waitcnt lgkmcnt(4)
    v_smfmac_f32_16x16x64_bf16 v[114:117], v[250:253], v[226:233], v254
    v_lshlrev_b32_sdwa v226, 3, v240 dst_sel:DWORD dst_unused:UNUSED_PAD src0_sel:DWORD src1_sel:WORD_0
    v_lshlrev_b32_sdwa v228, 3, v240 dst_sel:DWORD dst_unused:UNUSED_PAD src0_sel:DWORD src1_sel:WORD_1
    v_lshlrev_b32_sdwa v230, 3, v241 dst_sel:DWORD dst_unused:UNUSED_PAD src0_sel:DWORD src1_sel:WORD_0
    v_lshlrev_b32_sdwa v232, 3, v241 dst_sel:DWORD dst_unused:UNUSED_PAD src0_sel:DWORD src1_sel:WORD_1
    v_mfma_f32_32x32x16_bf16 v[194:209], v[58:61], v[154:157], v[194:209]
    ds_read_b64 v[226:227], v226
    ds_read_b64 v[228:229], v228
    ds_read_b64 v[230:231], v230
    ds_read_b64 v[232:233], v232
    buffer_load_dwordx4 v[238:241], v1, s[12:15], s28 offen offset:1024 sc1
    s_waitcnt lgkmcnt(4)
    v_smfmac_f32_16x16x64_bf16 v[114:117], v[250:253], v[218:225], v254
    s_waitcnt vmcnt(3)
    v_lshlrev_b32_sdwa v218, 3, v242 dst_sel:DWORD dst_unused:UNUSED_PAD src0_sel:DWORD src1_sel:WORD_0
    v_lshlrev_b32_sdwa v220, 3, v242 dst_sel:DWORD dst_unused:UNUSED_PAD src0_sel:DWORD src1_sel:WORD_1
    v_lshlrev_b32_sdwa v222, 3, v243 dst_sel:DWORD dst_unused:UNUSED_PAD src0_sel:DWORD src1_sel:WORD_0
    v_lshlrev_b32_sdwa v224, 3, v243 dst_sel:DWORD dst_unused:UNUSED_PAD src0_sel:DWORD src1_sel:WORD_1
    v_mfma_f32_32x32x16_bf16 v[194:209], v[62:65], v[158:161], v[194:209]
    ds_read_b64 v[218:219], v218
    ds_read_b64 v[220:221], v220
    ds_read_b64 v[222:223], v222
    ds_read_b64 v[224:225], v224
    s_waitcnt lgkmcnt(4)
    v_smfmac_f32_16x16x64_bf16 v[114:117], v[250:253], v[226:233], v254
    v_lshlrev_b32_sdwa v226, 3, v244 dst_sel:DWORD dst_unused:UNUSED_PAD src0_sel:DWORD src1_sel:WORD_0
    v_lshlrev_b32_sdwa v228, 3, v244 dst_sel:DWORD dst_unused:UNUSED_PAD src0_sel:DWORD src1_sel:WORD_1
    v_lshlrev_b32_sdwa v230, 3, v245 dst_sel:DWORD dst_unused:UNUSED_PAD src0_sel:DWORD src1_sel:WORD_0
    v_lshlrev_b32_sdwa v232, 3, v245 dst_sel:DWORD dst_unused:UNUSED_PAD src0_sel:DWORD src1_sel:WORD_1
    ds_read_b64 v[226:227], v226
    ds_read_b64 v[228:229], v228
    ds_read_b64 v[230:231], v230
    ds_read_b64 v[232:233], v232
    buffer_load_dwordx4 v[242:245], v1, s[12:15], s28 offen offset:2048 sc1
    s_waitcnt lgkmcnt(4)
    v_smfmac_f32_16x16x64_bf16 v[118:121], v[250:253], v[218:225], v254
    s_waitcnt vmcnt(3)
    v_lshlrev_b32_sdwa v218, 3, v246 dst_sel:DWORD dst_unused:UNUSED_PAD src0_sel:DWORD src1_sel:WORD_0
    v_lshlrev_b32_sdwa v220, 3, v246 dst_sel:DWORD dst_unused:UNUSED_PAD src0_sel:DWORD src1_sel:WORD_1
    v_lshlrev_b32_sdwa v222, 3, v247 dst_sel:DWORD dst_unused:UNUSED_PAD src0_sel:DWORD src1_sel:WORD_0
    v_lshlrev_b32_sdwa v224, 3, v247 dst_sel:DWORD dst_unused:UNUSED_PAD src0_sel:DWORD src1_sel:WORD_1
    v_cvt_pk_bf16_f32 v194, v194, v195
    v_cvt_pk_bf16_f32 v195, v196, v197
    v_cvt_pk_bf16_f32 v196, v198, v199
    v_cvt_pk_bf16_f32 v197, v200, v201
    v_cvt_pk_bf16_f32 v198, v202, v203
    ds_read_b64 v[218:219], v218
    ds_read_b64 v[220:221], v220
    ds_read_b64 v[222:223], v222
    ds_read_b64 v[224:225], v224
    s_waitcnt lgkmcnt(4)
    v_smfmac_f32_16x16x64_bf16 v[118:121], v[250:253], v[226:233], v254
    v_lshlrev_b32_sdwa v226, 3, v248 dst_sel:DWORD dst_unused:UNUSED_PAD src0_sel:DWORD src1_sel:WORD_0
    v_lshlrev_b32_sdwa v228, 3, v248 dst_sel:DWORD dst_unused:UNUSED_PAD src0_sel:DWORD src1_sel:WORD_1
    v_lshlrev_b32_sdwa v230, 3, v249 dst_sel:DWORD dst_unused:UNUSED_PAD src0_sel:DWORD src1_sel:WORD_0
    v_lshlrev_b32_sdwa v232, 3, v249 dst_sel:DWORD dst_unused:UNUSED_PAD src0_sel:DWORD src1_sel:WORD_1
    v_cvt_pk_bf16_f32 v199, v204, v205
    v_cvt_pk_bf16_f32 v200, v206, v207
    v_cvt_pk_bf16_f32 v201, v208, v209
    v_perm_b32 v209, v201, v217, s67
    v_perm_b32 v208, v201, v217, s66
    ds_read_b64 v[226:227], v226
    ds_read_b64 v[228:229], v228
    ds_read_b64 v[230:231], v230
    ds_read_b64 v[232:233], v232
    buffer_load_dwordx4 v[246:249], v1, s[12:15], s28 offen offset:3072 sc1
    s_add_u32 s28, s28, 4096
    s_add_u32 s28, s28, s47
    s_waitcnt lgkmcnt(4)
    v_smfmac_f32_16x16x64_bf16 v[118:121], v[250:253], v[218:225], v254
    s_waitcnt vmcnt(3)
    v_lshlrev_b32_sdwa v218, 3, v234 dst_sel:DWORD dst_unused:UNUSED_PAD src0_sel:DWORD src1_sel:WORD_0
    v_lshlrev_b32_sdwa v220, 3, v234 dst_sel:DWORD dst_unused:UNUSED_PAD src0_sel:DWORD src1_sel:WORD_1
    v_lshlrev_b32_sdwa v222, 3, v235 dst_sel:DWORD dst_unused:UNUSED_PAD src0_sel:DWORD src1_sel:WORD_0
    v_lshlrev_b32_sdwa v224, 3, v235 dst_sel:DWORD dst_unused:UNUSED_PAD src0_sel:DWORD src1_sel:WORD_1
    v_perm_b32 v207, v200, v216, s67
    v_perm_b32 v206, v200, v216, s66
    v_perm_b32 v205, v199, v215, s67
    v_perm_b32 v204, v199, v215, s66
    v_perm_b32 v203, v198, v214, s67
    ds_read_b64 v[218:219], v218
    ds_read_b64 v[220:221], v220
    ds_read_b64 v[222:223], v222
    ds_read_b64 v[224:225], v224
    v_and_b32 v146, 0x27f, v1
    buffer_load_dwordx4 v[146:149], v146, s[12:15], s26 offen sc1
    s_mov_b32 m0, s23
    s_waitcnt lgkmcnt(4)
    v_smfmac_f32_16x16x64_bf16 v[118:121], v[250:253], v[226:233], v254
    v_lshlrev_b32_sdwa v226, 3, v236 dst_sel:DWORD dst_unused:UNUSED_PAD src0_sel:DWORD src1_sel:WORD_0
    v_lshlrev_b32_sdwa v228, 3, v236 dst_sel:DWORD dst_unused:UNUSED_PAD src0_sel:DWORD src1_sel:WORD_1
    v_lshlrev_b32_sdwa v230, 3, v237 dst_sel:DWORD dst_unused:UNUSED_PAD src0_sel:DWORD src1_sel:WORD_0
    v_lshlrev_b32_sdwa v232, 3, v237 dst_sel:DWORD dst_unused:UNUSED_PAD src0_sel:DWORD src1_sel:WORD_1
    v_perm_b32 v202, v198, v214, s66
    v_perm_b32 v201, v197, v213, s67
    v_perm_b32 v200, v197, v213, s66
    v_perm_b32 v199, v196, v212, s67
    v_perm_b32 v198, v196, v212, s66
    ds_read_b64 v[226:227], v226
    ds_read_b64 v[228:229], v228
    ds_read_b64 v[230:231], v230
    ds_read_b64 v[232:233], v232
    buffer_load_dwordx4 v[234:237], v1, s[12:15], s28 offen offset:0 sc1
    s_waitcnt lgkmcnt(4)
    v_smfmac_f32_16x16x64_bf16 v[122:125], v[250:253], v[218:225], v254
    s_waitcnt vmcnt(4)
    v_lshlrev_b32_sdwa v218, 3, v238 dst_sel:DWORD dst_unused:UNUSED_PAD src0_sel:DWORD src1_sel:WORD_0
    v_lshlrev_b32_sdwa v220, 3, v238 dst_sel:DWORD dst_unused:UNUSED_PAD src0_sel:DWORD src1_sel:WORD_1
    v_lshlrev_b32_sdwa v222, 3, v239 dst_sel:DWORD dst_unused:UNUSED_PAD src0_sel:DWORD src1_sel:WORD_0
    v_lshlrev_b32_sdwa v224, 3, v239 dst_sel:DWORD dst_unused:UNUSED_PAD src0_sel:DWORD src1_sel:WORD_1
    v_perm_b32 v197, v195, v211, s67
    v_perm_b32 v196, v195, v211, s66
    v_perm_b32 v195, v194, v210, s67
    v_perm_b32 v194, v194, v210, s66
    ds_read_b64 v[218:219], v218
    ds_read_b64 v[220:221], v220
    ds_read_b64 v[222:223], v222
    ds_read_b64 v[224:225], v224
    s_waitcnt lgkmcnt(4)
    v_smfmac_f32_16x16x64_bf16 v[122:125], v[250:253], v[226:233], v254
    v_lshlrev_b32_sdwa v226, 3, v240 dst_sel:DWORD dst_unused:UNUSED_PAD src0_sel:DWORD src1_sel:WORD_0
    v_lshlrev_b32_sdwa v228, 3, v240 dst_sel:DWORD dst_unused:UNUSED_PAD src0_sel:DWORD src1_sel:WORD_1
    v_lshlrev_b32_sdwa v230, 3, v241 dst_sel:DWORD dst_unused:UNUSED_PAD src0_sel:DWORD src1_sel:WORD_0
    v_lshlrev_b32_sdwa v232, 3, v241 dst_sel:DWORD dst_unused:UNUSED_PAD src0_sel:DWORD src1_sel:WORD_1
    ds_read_b64 v[226:227], v226
    ds_read_b64 v[228:229], v228
    ds_read_b64 v[230:231], v230
    ds_read_b64 v[232:233], v232
    buffer_load_dwordx4 v[238:241], v1, s[12:15], s28 offen offset:1024 sc1
    s_waitcnt lgkmcnt(4)
    v_smfmac_f32_16x16x64_bf16 v[122:125], v[250:253], v[218:225], v254
    s_waitcnt vmcnt(4)
    v_lshlrev_b32_sdwa v218, 3, v242 dst_sel:DWORD dst_unused:UNUSED_PAD src0_sel:DWORD src1_sel:WORD_0
    v_lshlrev_b32_sdwa v220, 3, v242 dst_sel:DWORD dst_unused:UNUSED_PAD src0_sel:DWORD src1_sel:WORD_1
    v_lshlrev_b32_sdwa v222, 3, v243 dst_sel:DWORD dst_unused:UNUSED_PAD src0_sel:DWORD src1_sel:WORD_0
    v_lshlrev_b32_sdwa v224, 3, v243 dst_sel:DWORD dst_unused:UNUSED_PAD src0_sel:DWORD src1_sel:WORD_1
    ds_read_b64 v[218:219], v218
    ds_read_b64 v[220:221], v220
    ds_read_b64 v[222:223], v222
    ds_read_b64 v[224:225], v224
    s_waitcnt lgkmcnt(4)
    v_smfmac_f32_16x16x64_bf16 v[122:125], v[250:253], v[226:233], v254
    v_lshlrev_b32_sdwa v226, 3, v244 dst_sel:DWORD dst_unused:UNUSED_PAD src0_sel:DWORD src1_sel:WORD_0
    v_lshlrev_b32_sdwa v228, 3, v244 dst_sel:DWORD dst_unused:UNUSED_PAD src0_sel:DWORD src1_sel:WORD_1
    v_lshlrev_b32_sdwa v230, 3, v245 dst_sel:DWORD dst_unused:UNUSED_PAD src0_sel:DWORD src1_sel:WORD_0
    v_lshlrev_b32_sdwa v232, 3, v245 dst_sel:DWORD dst_unused:UNUSED_PAD src0_sel:DWORD src1_sel:WORD_1
    ds_read_b64 v[226:227], v226
    ds_read_b64 v[228:229], v228
    ds_read_b64 v[230:231], v230
    ds_read_b64 v[232:233], v232
    buffer_load_dwordx4 v[242:245], v1, s[12:15], s28 offen offset:2048 sc1
    s_waitcnt lgkmcnt(4)
    v_smfmac_f32_16x16x64_bf16 v[126:129], v[250:253], v[218:225], v254
    s_waitcnt vmcnt(4)
    v_lshlrev_b32_sdwa v218, 3, v246 dst_sel:DWORD dst_unused:UNUSED_PAD src0_sel:DWORD src1_sel:WORD_0
    v_lshlrev_b32_sdwa v220, 3, v246 dst_sel:DWORD dst_unused:UNUSED_PAD src0_sel:DWORD src1_sel:WORD_1
    v_lshlrev_b32_sdwa v222, 3, v247 dst_sel:DWORD dst_unused:UNUSED_PAD src0_sel:DWORD src1_sel:WORD_0
    v_lshlrev_b32_sdwa v224, 3, v247 dst_sel:DWORD dst_unused:UNUSED_PAD src0_sel:DWORD src1_sel:WORD_1
    ds_read_b64 v[218:219], v218
    ds_read_b64 v[220:221], v220
    ds_read_b64 v[222:223], v222
    ds_read_b64 v[224:225], v224
    s_waitcnt lgkmcnt(4)
    v_smfmac_f32_16x16x64_bf16 v[126:129], v[250:253], v[226:233], v254
    v_lshlrev_b32_sdwa v226, 3, v248 dst_sel:DWORD dst_unused:UNUSED_PAD src0_sel:DWORD src1_sel:WORD_0
    v_lshlrev_b32_sdwa v228, 3, v248 dst_sel:DWORD dst_unused:UNUSED_PAD src0_sel:DWORD src1_sel:WORD_1
    v_lshlrev_b32_sdwa v230, 3, v249 dst_sel:DWORD dst_unused:UNUSED_PAD src0_sel:DWORD src1_sel:WORD_0
    v_lshlrev_b32_sdwa v232, 3, v249 dst_sel:DWORD dst_unused:UNUSED_PAD src0_sel:DWORD src1_sel:WORD_1
    ds_read_b64 v[226:227], v226
    ds_read_b64 v[228:229], v228
    ds_read_b64 v[230:231], v230
    ds_read_b64 v[232:233], v232
    buffer_load_dwordx4 v[246:249], v1, s[12:15], s28 offen offset:3072 sc1
    s_add_u32 s28, s28, 4096
    s_waitcnt lgkmcnt(4)
    v_smfmac_f32_16x16x64_bf16 v[126:129], v[250:253], v[218:225], v254
    s_waitcnt lgkmcnt(0)
    s_barrier
    s_setprio 3
    ds_write_addtid_b32 v162 offset:0
    ds_write_addtid_b32 v163 offset:256
    ds_write_addtid_b32 v164 offset:512
    ds_write_addtid_b32 v165 offset:768
    v_smfmac_f32_16x16x64_bf16 v[126:129], v[250:253], v[226:233], v254
    ds_write_addtid_b32 v166 offset:1024
    ds_write_addtid_b32 v167 offset:1280
    ds_write_addtid_b32 v168 offset:1536
    ds_write_addtid_b32 v169 offset:1792
    ds_write_addtid_b32 v170 offset:2048
    v_lshrrev_b32 v210, 5, v0
    ds_write_addtid_b32 v171 offset:2304
    v_lshlrev_b32 v210, 7, v210
    ds_write_addtid_b32 v172 offset:2560
    v_and_b32 v211, 7, v0
    ds_write_addtid_b32 v173 offset:2816
    v_lshl_add_u32 v210, v211, 4, v210
    ds_write_addtid_b32 v174 offset:3072
    s_lshl_b32 s20, s22, 8
    ds_write_addtid_b32 v175 offset:3328
    s_add_u32 s20, s20, 128000
    ds_write_addtid_b32 v176 offset:3584
    v_add_u32 v210, s20, v210
    ds_write_addtid_b32 v177 offset:3840
    v_and_b32 v214, 1, v0
    s_setprio 2
    ds_write_addtid_b32 v178 offset:4096
    v_lshlrev_b32 v214, 10, v214
    ds_write_addtid_b32 v179 offset:4352
    v_bfe_u32 v215, v0, 1, 1
    ds_write_addtid_b32 v180 offset:4608
    v_lshl_add_u32 v214, v215, 4, v214
    ds_write_addtid_b32 v181 offset:4864
    v_bfe_u32 v215, v0, 3, 1
    ds_write_addtid_b32 v182 offset:5120
    v_lshl_add_u32 v214, v215, 5, v214
    ds_write_addtid_b32 v183 offset:5376
    v_bfe_u32 v215, v0, 2, 1
    ds_write_addtid_b32 v184 offset:5632
    v_lshl_add_u32 v214, v215, 6, v214
    ds_write_addtid_b32 v185 offset:5888
    v_lshrrev_b32 v215, 5, v0
    ds_write_addtid_b32 v186 offset:6144
    v_lshl_add_u32 v214, v215, 7, v214
    ds_write_addtid_b32 v187 offset:6400
    v_add_u32 v214, 128000, v214
    ds_write_addtid_b32 v188 offset:6656
    v_mov_b32 v212, 130048
    ds_write_addtid_b32 v189 offset:6912
    v_mov_b32 v211, 0
    ds_write_addtid_b32 v190 offset:7168
    ds_write_b32 v212, v211
    ds_write_addtid_b32 v191 offset:7424
    s_and_b32 s27, s24, 1
    ds_write_addtid_b32 v192 offset:7680
    s_xor_b32 s27, s27, 1
    ds_write_addtid_b32 v193 offset:7936
    s_lshl_b32 s47, s27, 14
    s_setprio 1
    s_mov_b32 m0, s30
    s_nop 0
    ds_write_addtid_b32 v130 offset:57472
    v_lshlrev_b32 v255, 3, v0
    ds_write_addtid_b32 v131 offset:57728
    s_waitcnt vmcnt(3)
    ds_write_addtid_b32 v132 offset:57984
    v_lshlrev_b32_sdwa v218, 3, v234 dst_sel:DWORD dst_unused:UNUSED_PAD src0_sel:DWORD src1_sel:WORD_0
    ds_write_addtid_b32 v133 offset:58240
    v_lshlrev_b32_sdwa v220, 3, v234 dst_sel:DWORD dst_unused:UNUSED_PAD src0_sel:DWORD src1_sel:WORD_1
    ds_write_addtid_b32 v134 offset:58496
    v_lshlrev_b32_sdwa v222, 3, v235 dst_sel:DWORD dst_unused:UNUSED_PAD src0_sel:DWORD src1_sel:WORD_0
    ds_write_addtid_b32 v135 offset:58752
    v_lshlrev_b32_sdwa v224, 3, v235 dst_sel:DWORD dst_unused:UNUSED_PAD src0_sel:DWORD src1_sel:WORD_1
    ds_write_addtid_b32 v136 offset:59008
    v_lshlrev_b32_sdwa v226, 3, v236 dst_sel:DWORD dst_unused:UNUSED_PAD src0_sel:DWORD src1_sel:WORD_0
    ds_write_addtid_b32 v137 offset:59264
    v_lshlrev_b32_sdwa v228, 3, v236 dst_sel:DWORD dst_unused:UNUSED_PAD src0_sel:DWORD src1_sel:WORD_1
    ds_write_addtid_b32 v138 offset:59520
    v_lshlrev_b32_sdwa v230, 3, v237 dst_sel:DWORD dst_unused:UNUSED_PAD src0_sel:DWORD src1_sel:WORD_0
    ds_write_addtid_b32 v139 offset:59776
    v_lshlrev_b32_sdwa v232, 3, v237 dst_sel:DWORD dst_unused:UNUSED_PAD src0_sel:DWORD src1_sel:WORD_1
    ds_write_addtid_b32 v140 offset:60032
    ds_write_addtid_b32 v141 offset:60288
    ds_write_addtid_b32 v142 offset:60544
    ds_write_addtid_b32 v143 offset:60800
    ds_write_addtid_b32 v144 offset:61056
    ds_write_addtid_b32 v145 offset:61312
    s_setprio 0
    ds_write_addtid_b32 v194 offset:61568
    ds_write_addtid_b32 v195 offset:61824
    ds_write_addtid_b32 v196 offset:62080
    s_waitcnt vmcnt(0)
    ds_write_b128 v210, v[146:149]
    buffer_load_dwordx4 v[234:237], v1, s[12:15], s28 offen sc1
    ds_write_addtid_b32 v197 offset:62336
    s_cmp_eq_u32 s22, 7
    s_cbranch_scc1 W_e1
    ds_write_addtid_b32 v198 offset:62592
    ds_write_addtid_b32 v199 offset:62848
    ds_write_addtid_b32 v200 offset:63104
    ds_write_addtid_b32 v201 offset:63360
    ds_write_addtid_b32 v202 offset:63616
    ds_write_addtid_b32 v203 offset:63872
    ds_write_addtid_b32 v204 offset:64128
    ds_write_addtid_b32 v205 offset:64384
    ds_write_addtid_b32 v206 offset:64640
    ds_write_addtid_b32 v207 offset:64896
    ds_write_addtid_b32 v208 offset:65152
    ds_write_addtid_b32 v209 offset:65408
W_e1:
    s_cmp_lg_u32 s22, 7
    s_cbranch_scc1 L_Glast
    v_and_b32 v210, 7, v0
    v_bfe_u32 v211, v0, 3, 1
    v_lshl_add_u32 v210, v211, 5, v210
    v_lshrrev_b32 v211, 4, v0
    v_lshl_add_u32 v210, v211, 3, v210
    v_mul_u32_u24 v210, 26, v210
    v_add_u32 v210, 156672, v210
    v_mov_b32 v211, 158720
    v_lshl_add_u32 v212, v0, 2, v211
    ds_read_u16_d16_hi v146, v210 offset:0
    ds_read_u16_d16_hi v147, v210 offset:2
    ds_read_u16_d16_hi v148, v210 offset:4
    ds_read_u16_d16_hi v149, v210 offset:6
    ds_read_u16_d16_hi v150, v210 offset:8
    ds_read_u16_d16_hi v151, v210 offset:10
    ds_read_u16_d16_hi v152, v210 offset:12
    ds_read_u16_d16_hi v153, v210 offset:14
    ds_read_u16_d16_hi v154, v210 offset:16
    ds_read_u16_d16_hi v155, v210 offset:18
    ds_read_u16_d16_hi v156, v210 offset:20
    ds_read_u16_d16_hi v157, v210 offset:22
    ds_read_u16_d16_hi v158, v210 offset:24
    ds_read_u16_d16_hi v159, v211
    ds_read_u16_d16_hi v160, v211 offset:256
    ds_read_u16_d16_hi v161, v212 offset:512
L_Glast:
    s_setprio 3
    s_waitcnt lgkmcnt(0)
    s_barrier
    ds_read_b128 v[130:133], v214 offset:0
    ds_read_b128 v[134:137], v214 offset:256
    ds_read_b128 v[138:141], v214 offset:512
    ds_read_b128 v[142:145], v214 offset:768
    ds_read_b64 v[218:219], v218
    ds_read_b64 v[220:221], v220
    ds_read_b64 v[222:223], v222
    ds_read_b64 v[224:225], v224
    ds_read_b64 v[226:227], v226
    ds_read_b64 v[228:229], v228
    ds_read_b64 v[230:231], v230
    ds_read_b64 v[232:233], v232
    s_waitcnt lgkmcnt(4)
    v_smfmac_f32_16x16x64_bf16 v[66:69], v[250:253], v[218:225], v254
    s_waitcnt vmcnt(3)
    v_lshlrev_b32_sdwa v218, 3, v238 dst_sel:DWORD dst_unused:UNUSED_PAD src0_sel:DWORD src1_sel:WORD_0
    v_lshlrev_b32_sdwa v220, 3, v238 dst_sel:DWORD dst_unused:UNUSED_PAD src0_sel:DWORD src1_sel:WORD_1
    v_lshlrev_b32_sdwa v222, 3, v239 dst_sel:DWORD dst_unused:UNUSED_PAD src0_sel:DWORD src1_sel:WORD_0
    v_lshlrev_b32_sdwa v224, 3, v239 dst_sel:DWORD dst_unused:UNUSED_PAD src0_sel:DWORD src1_sel:WORD_1
    ds_read_b64 v[218:219], v218
    ds_read_b64 v[220:221], v220
    ds_read_b64 v[222:223], v222
    ds_read_b64 v[224:225], v224
    s_cmp_lg_u32 s22, 0
    s_cbranch_scc1 G_nf2
    s_lshl_b32 s31, s34, 3
    s_add_u32 s31, s31, 16809984
    v_mov_b32 v212, 0
    v_mov_b32 v210, s64
    v_mov_b32 v211, s65
    s_mov_b64 exec, 1
    buffer_store_dwordx2 v[210:211], v212, s[12:15], s31 offen sc1
    s_mov_b64 exec, -1
G_nf2:
    s_waitcnt lgkmcnt(4)
    v_smfmac_f32_16x16x64_bf16 v[66:69], v[250:253], v[226:233], v254
    v_lshlrev_b32_sdwa v226, 3, v240 dst_sel:DWORD dst_unused:UNUSED_PAD src0_sel:DWORD src1_sel:WORD_0
    v_lshlrev_b32_sdwa v228, 3, v240 dst_sel:DWORD dst_unused:UNUSED_PAD src0_sel:DWORD src1_sel:WORD_1
    v_lshlrev_b32_sdwa v230, 3, v241 dst_sel:DWORD dst_unused:UNUSED_PAD src0_sel:DWORD src1_sel:WORD_0
    v_lshlrev_b32_sdwa v232, 3, v241 dst_sel:DWORD dst_unused:UNUSED_PAD src0_sel:DWORD src1_sel:WORD_1
    v_and_b32 v216, 24, v0
    v_and_b32 v217, 3, v0
    v_lshl_add_u32 v216, v217, 1, v216
    v_bfe_u32 v217, v0, 2, 1
    v_add_u32 v216, v216, v217
    v_lshlrev_b32 v216, 5, v216
    ds_read_b64 v[226:227], v226
    ds_read_b64 v[228:229], v228
    ds_read_b64 v[230:231], v230
    ds_read_b64 v[232:233], v232
    buffer_load_dwordx4 v[238:241], v1, s[12:15], s28 offen offset:1024 sc1
    s_waitcnt lgkmcnt(4)
    v_smfmac_f32_16x16x64_bf16 v[66:69], v[250:253], v[218:225], v254
    s_waitcnt vmcnt(3)
    v_lshlrev_b32_sdwa v218, 3, v242 dst_sel:DWORD dst_unused:UNUSED_PAD src0_sel:DWORD src1_sel:WORD_0
    v_lshlrev_b32_sdwa v220, 3, v242 dst_sel:DWORD dst_unused:UNUSED_PAD src0_sel:DWORD src1_sel:WORD_1
    v_lshlrev_b32_sdwa v222, 3, v243 dst_sel:DWORD dst_unused:UNUSED_PAD src0_sel:DWORD src1_sel:WORD_0
    v_lshlrev_b32_sdwa v224, 3, v243 dst_sel:DWORD dst_unused:UNUSED_PAD src0_sel:DWORD src1_sel:WORD_1
    v_lshrrev_b32 v214, 5, v0
    v_bfe_u32 v217, v0, 1, 1
    v_xor_b32 v217, v217, v214
    v_lshl_add_u32 v216, v217, 4, v216
    s_lshl_b32 s31, s22, 11
    s_add_u32 s31, s31, 131072
    v_add_u32 v216, s31, v216
    ds_read_b64 v[218:219], v218
    ds_read_b64 v[220:221], v220
    ds_read_b64 v[222:223], v222
    ds_read_b64 v[224:225], v224
    s_waitcnt lgkmcnt(4)
    v_smfmac_f32_16x16x64_bf16 v[66:69], v[250:253], v[226:233], v254
    v_lshlrev_b32_sdwa v226, 3, v244 dst_sel:DWORD dst_unused:UNUSED_PAD src0_sel:DWORD src1_sel:WORD_0
    v_lshlrev_b32_sdwa v228, 3, v244 dst_sel:DWORD dst_unused:UNUSED_PAD src0_sel:DWORD src1_sel:WORD_1
    v_lshlrev_b32_sdwa v230, 3, v245 dst_sel:DWORD dst_unused:UNUSED_PAD src0_sel:DWORD src1_sel:WORD_0
    v_lshlrev_b32_sdwa v232, 3, v245 dst_sel:DWORD dst_unused:UNUSED_PAD src0_sel:DWORD src1_sel:WORD_1
    v_mfma_f32_32x32x16_bf16 v[162:177], v[130:133], v[2:5], 0
    ds_read_b64 v[226:227], v226
    ds_read_b64 v[228:229], v228
    ds_read_b64 v[230:231], v230
    ds_read_b64 v[232:233], v232
    buffer_load_dwordx4 v[242:245], v1, s[12:15], s28 offen offset:2048 sc1
    s_waitcnt lgkmcnt(4)
    v_smfmac_f32_16x16x64_bf16 v[70:73], v[250:253], v[218:225], v254
    s_waitcnt vmcnt(3)
    v_lshlrev_b32_sdwa v218, 3, v246 dst_sel:DWORD dst_unused:UNUSED_PAD src0_sel:DWORD src1_sel:WORD_0
    v_lshlrev_b32_sdwa v220, 3, v246 dst_sel:DWORD dst_unused:UNUSED_PAD src0_sel:DWORD src1_sel:WORD_1
    v_lshlrev_b32_sdwa v222, 3, v247 dst_sel:DWORD dst_unused:UNUSED_PAD src0_sel:DWORD src1_sel:WORD_0
    v_lshlrev_b32_sdwa v224, 3, v247 dst_sel:DWORD dst_unused:UNUSED_PAD src0_sel:DWORD src1_sel:WORD_1
    v_mfma_f32_32x32x16_bf16 v[162:177], v[134:137], v[6:9], v[162:177]
    ds_read_b64 v[218:219], v218
    ds_read_b64 v[220:221], v220
    ds_read_b64 v[222:223], v222
    ds_read_b64 v[224:225], v224
    s_waitcnt lgkmcnt(4)
    v_smfmac_f32_16x16x64_bf16 v[70:73], v[250:253], v[226:233], v254
    v_lshlrev_b32_sdwa v226, 3, v248 dst_sel:DWORD dst_unused:UNUSED_PAD src0_sel:DWORD src1_sel:WORD_0
    v_lshlrev_b32_sdwa v228, 3, v248 dst_sel:DWORD dst_unused:UNUSED_PAD src0_sel:DWORD src1_sel:WORD_1
    v_lshlrev_b32_sdwa v230, 3, v249 dst_sel:DWORD dst_unused:UNUSED_PAD src0_sel:DWORD src1_sel:WORD_0
    v_lshlrev_b32_sdwa v232, 3, v249 dst_sel:DWORD dst_unused:UNUSED_PAD src0_sel:DWORD src1_sel:WORD_1
    v_mfma_f32_32x32x16_bf16 v[162:177], v[138:141], v[10:13], v[162:177]
    ds_read_b64 v[226:227], v226
    ds_read_b64 v[228:229], v228
    ds_read_b64 v[230:231], v230
    ds_read_b64 v[232:233], v232
    buffer_load_dwordx4 v[246:249], v1, s[12:15], s28 offen offset:3072 sc1
    s_add_u32 s28, s28, 4096
    s_waitcnt lgkmcnt(4)
    v_smfmac_f32_16x16x64_bf16 v[70:73], v[250:253], v[218:225], v254
    s_waitcnt vmcnt(3)
    v_lshlrev_b32_sdwa v218, 3, v234 dst_sel:DWORD dst_unused:UNUSED_PAD src0_sel:DWORD src1_sel:WORD_0
    v_lshlrev_b32_sdwa v220, 3, v234 dst_sel:DWORD dst_unused:UNUSED_PAD src0_sel:DWORD src1_sel:WORD_1
    v_lshlrev_b32_sdwa v222, 3, v235 dst_sel:DWORD dst_unused:UNUSED_PAD src0_sel:DWORD src1_sel:WORD_0
    v_lshlrev_b32_sdwa v224, 3, v235 dst_sel:DWORD dst_unused:UNUSED_PAD src0_sel:DWORD src1_sel:WORD_1
    v_mfma_f32_32x32x16_bf16 v[162:177], v[142:145], v[14:17], v[162:177]
    ds_read_b64 v[218:219], v218
    ds_read_b64 v[220:221], v220
    ds_read_b64 v[222:223], v222
    ds_read_b64 v[224:225], v224
    s_waitcnt lgkmcnt(4)
    v_smfmac_f32_16x16x64_bf16 v[70:73], v[250:253], v[226:233], v254
    v_lshlrev_b32_sdwa v226, 3, v236 dst_sel:DWORD dst_unused:UNUSED_PAD src0_sel:DWORD src1_sel:WORD_0
    v_lshlrev_b32_sdwa v228, 3, v236 dst_sel:DWORD dst_unused:UNUSED_PAD src0_sel:DWORD src1_sel:WORD_1
    v_lshlrev_b32_sdwa v230, 3, v237 dst_sel:DWORD dst_unused:UNUSED_PAD src0_sel:DWORD src1_sel:WORD_0
    v_lshlrev_b32_sdwa v232, 3, v237 dst_sel:DWORD dst_unused:UNUSED_PAD src0_sel:DWORD src1_sel:WORD_1
    v_mfma_f32_32x32x16_bf16 v[178:193], v[130:133], v[18:21], 0
    ds_read_b64 v[226:227], v226
    ds_read_b64 v[228:229], v228
    ds_read_b64 v[230:231], v230
    ds_read_b64 v[232:233], v232
    buffer_load_dwordx4 v[234:237], v1, s[12:15], s28 offen offset:0 sc1
    s_waitcnt lgkmcnt(4)
    v_smfmac_f32_16x16x64_bf16 v[74:77], v[250:253], v[218:225], v254
    s_waitcnt vmcnt(3)
    v_lshlrev_b32_sdwa v218, 3, v238 dst_sel:DWORD dst_unused:UNUSED_PAD src0_sel:DWORD src1_sel:WORD_0
    v_lshlrev_b32_sdwa v220, 3, v238 dst_sel:DWORD dst_unused:UNUSED_PAD src0_sel:DWORD src1_sel:WORD_1
    v_lshlrev_b32_sdwa v222, 3, v239 dst_sel:DWORD dst_unused:UNUSED_PAD src0_sel:DWORD src1_sel:WORD_0
    v_lshlrev_b32_sdwa v224, 3, v239 dst_sel:DWORD dst_unused:UNUSED_PAD src0_sel:DWORD src1_sel:WORD_1
    v_cvt_pk_bf16_f32 v162, v162, v163
    v_cvt_pk_bf16_f32 v163, v164, v165
    v_cvt_pk_bf16_f32 v164, v166, v167
    v_cvt_pk_bf16_f32 v165, v168, v169
    v_mfma_f32_32x32x16_bf16 v[178:193], v[134:137], v[22:25], v[178:193]
    ds_read_b64 v[218:219], v218
    ds_read_b64 v[220:221], v220
    ds_read_b64 v[222:223], v222
    ds_read_b64 v[224:225], v224
    ds_write_b128 v216, v[162:165] offset:0
    s_waitcnt lgkmcnt(4)
    v_smfmac_f32_16x16x64_bf16 v[74:77], v[250:253], v[226:233], v254
    v_lshlrev_b32_sdwa v226, 3, v240 dst_sel:DWORD dst_unused:UNUSED_PAD src0_sel:DWORD src1_sel:WORD_0
    v_lshlrev_b32_sdwa v228, 3, v240 dst_sel:DWORD dst_unused:UNUSED_PAD src0_sel:DWORD src1_sel:WORD_1
    v_lshlrev_b32_sdwa v230, 3, v241 dst_sel:DWORD dst_unused:UNUSED_PAD src0_sel:DWORD src1_sel:WORD_0
    v_lshlrev_b32_sdwa v232, 3, v241 dst_sel:DWORD dst_unused:UNUSED_PAD src0_sel:DWORD src1_sel:WORD_1
    v_cvt_pk_bf16_f32 v66, v66, v67
    v_cvt_pk_bf16_f32 v67, v68, v69
    v_cvt_pk_bf16_f32 v68, v70, v71
    v_cvt_pk_bf16_f32 v69, v72, v73
    v_mfma_f32_32x32x16_bf16 v[178:193], v[138:141], v[26:29], v[178:193]
    ds_read_b64 v[226:227], v226
    ds_read_b64 v[228:229], v228
    ds_read_b64 v[230:231], v230
    ds_read_b64 v[232:233], v232
    buffer_load_dwordx4 v[238:241], v1, s[12:15], s28 offen offset:1024 sc1
    buffer_store_dwordx4 v[66:69], v1, s[12:15], s3 offen offset:0 sc1
    s_waitcnt lgkmcnt(4)
    v_smfmac_f32_16x16x64_bf16 v[74:77], v[250:253], v[218:225], v254
    s_waitcnt vmcnt(4)
    v_lshlrev_b32_sdwa v218, 3, v242 dst_sel:DWORD dst_unused:UNUSED_PAD src0_sel:DWORD src1_sel:WORD_0
    v_lshlrev_b32_sdwa v220, 3, v242 dst_sel:DWORD dst_unused:UNUSED_PAD src0_sel:DWORD src1_sel:WORD_1
    v_lshlrev_b32_sdwa v222, 3, v243 dst_sel:DWORD dst_unused:UNUSED_PAD src0_sel:DWORD src1_sel:WORD_0
    v_lshlrev_b32_sdwa v224, 3, v243 dst_sel:DWORD dst_unused:UNUSED_PAD src0_sel:DWORD src1_sel:WORD_1
    v_mfma_f32_32x32x16_bf16 v[178:193], v[142:145], v[30:33], v[178:193]
    ds_read_b64 v[218:219], v218
    ds_read_b64 v[220:221], v220
    ds_read_b64 v[222:223], v222
    ds_read_b64 v[224:225], v224
    s_waitcnt lgkmcnt(4)
    v_smfmac_f32_16x16x64_bf16 v[74:77], v[250:253], v[226:233], v254
    v_lshlrev_b32_sdwa v226, 3, v244 dst_sel:DWORD dst_unused:UNUSED_PAD src0_sel:DWORD src1_sel:WORD_0
    v_lshlrev_b32_sdwa v228, 3, v244 dst_sel:DWORD dst_unused:UNUSED_PAD src0_sel:DWORD src1_sel:WORD_1
    v_lshlrev_b32_sdwa v230, 3, v245 dst_sel:DWORD dst_unused:UNUSED_PAD src0_sel:DWORD src1_sel:WORD_0
    v_lshlrev_b32_sdwa v232, 3, v245 dst_sel:DWORD dst_unused:UNUSED_PAD src0_sel:DWORD src1_sel:WORD_1
    v_mfma_f32_32x32x16_bf16 v[194:209], v[130:133], v[34:37], 0
    ds_read_b64 v[226:227], v226
    ds_read_b64 v[228:229], v228
    ds_read_b64 v[230:231], v230
    ds_read_b64 v[232:233], v232
    buffer_load_dwordx4 v[242:245], v1, s[12:15], s28 offen offset:2048 sc1
    s_waitcnt lgkmcnt(4)
    v_smfmac_f32_16x16x64_bf16 v[78:81], v[250:253], v[218:225], v254
    s_waitcnt vmcnt(4)
    v_lshlrev_b32_sdwa v218, 3, v246 dst_sel:DWORD dst_unused:UNUSED_PAD src0_sel:DWORD src1_sel:WORD_0
    v_lshlrev_b32_sdwa v220, 3, v246 dst_sel:DWORD dst_unused:UNUSED_PAD src0_sel:DWORD src1_sel:WORD_1
    v_lshlrev_b32_sdwa v222, 3, v247 dst_sel:DWORD dst_unused:UNUSED_PAD src0_sel:DWORD src1_sel:WORD_0
    v_lshlrev_b32_sdwa v224, 3, v247 dst_sel:DWORD dst_unused:UNUSED_PAD src0_sel:DWORD src1_sel:WORD_1
    v_cvt_pk_bf16_f32 v178, v178, v179
    v_cvt_pk_bf16_f32 v179, v180, v181
    v_cvt_pk_bf16_f32 v180, v182, v183
    v_cvt_pk_bf16_f32 v181, v184, v185
    v_mfma_f32_32x32x16_bf16 v[194:209], v[134:137], v[38:41], v[194:209]
    ds_read_b64 v[218:219], v218
    ds_read_b64 v[220:221], v220
    ds_read_b64 v[222:223], v222
    ds_read_b64 v[224:225], v224
    ds_write_b128 v216, v[178:181] offset:1024
    s_waitcnt lgkmcnt(4)
    v_smfmac_f32_16x16x64_bf16 v[78:81], v[250:253], v[226:233], v254
    v_lshlrev_b32_sdwa v226, 3, v248 dst_sel:DWORD dst_unused:UNUSED_PAD src0_sel:DWORD src1_sel:WORD_0
    v_lshlrev_b32_sdwa v228, 3, v248 dst_sel:DWORD dst_unused:UNUSED_PAD src0_sel:DWORD src1_sel:WORD_1
    v_lshlrev_b32_sdwa v230, 3, v249 dst_sel:DWORD dst_unused:UNUSED_PAD src0_sel:DWORD src1_sel:WORD_0
    v_lshlrev_b32_sdwa v232, 3, v249 dst_sel:DWORD dst_unused:UNUSED_PAD src0_sel:DWORD src1_sel:WORD_1
    v_mfma_f32_32x32x16_bf16 v[194:209], v[138:141], v[42:45], v[194:209]
    ds_read_b64 v[226:227], v226
    ds_read_b64 v[228:229], v228
    ds_read_b64 v[230:231], v230
    ds_read_b64 v[232:233], v232
    buffer_load_dwordx4 v[246:249], v1, s[12:15], s28 offen offset:3072 sc1
    s_add_u32 s28, s28, 4096
    s_setprio 2
    s_waitcnt lgkmcnt(4)
    v_smfmac_f32_16x16x64_bf16 v[78:81], v[250:253], v[218:225], v254
    s_waitcnt vmcnt(4)
    v_lshlrev_b32_sdwa v218, 3, v234 dst_sel:DWORD dst_unused:UNUSED_PAD src0_sel:DWORD src1_sel:WORD_0
    v_lshlrev_b32_sdwa v220, 3, v234 dst_sel:DWORD dst_unused:UNUSED_PAD src0_sel:DWORD src1_sel:WORD_1
    v_lshlrev_b32_sdwa v222, 3, v235 dst_sel:DWORD dst_unused:UNUSED_PAD src0_sel:DWORD src1_sel:WORD_0
    v_lshlrev_b32_sdwa v224, 3, v235 dst_sel:DWORD dst_unused:UNUSED_PAD src0_sel:DWORD src1_sel:WORD_1
    v_mfma_f32_32x32x16_bf16 v[194:209], v[142:145], v[46:49], v[194:209]
    ds_read_b64 v[218:219], v218
    ds_read_b64 v[220:221], v220
    ds_read_b64 v[222:223], v222
    ds_read_b64 v[224:225], v224
    s_waitcnt lgkmcnt(4)
    v_smfmac_f32_16x16x64_bf16 v[78:81], v[250:253], v[226:233], v254
    v_lshlrev_b32_sdwa v226, 3, v236 dst_sel:DWORD dst_unused:UNUSED_PAD src0_sel:DWORD src1_sel:WORD_0
    v_lshlrev_b32_sdwa v228, 3, v236 dst_sel:DWORD dst_unused:UNUSED_PAD src0_sel:DWORD src1_sel:WORD_1
    v_lshlrev_b32_sdwa v230, 3, v237 dst_sel:DWORD dst_unused:UNUSED_PAD src0_sel:DWORD src1_sel:WORD_0
    v_lshlrev_b32_sdwa v232, 3, v237 dst_sel:DWORD dst_unused:UNUSED_PAD src0_sel:DWORD src1_sel:WORD_1
    v_mfma_f32_32x32x16_bf16 v[162:177], v[130:133], v[50:53], 0
    ds_read_b64 v[226:227], v226
    ds_read_b64 v[228:229], v228
    ds_read_b64 v[230:231], v230
    ds_read_b64 v[232:233], v232
    buffer_load_dwordx4 v[234:237], v1, s[12:15], s28 offen offset:0 sc1
    s_waitcnt lgkmcnt(4)
    v_smfmac_f32_16x16x64_bf16 v[82:85], v[250:253], v[218:225], v254
    s_waitcnt vmcnt(4)
    v_lshlrev_b32_sdwa v218, 3, v238 dst_sel:DWORD dst_unused:UNUSED_PAD src0_sel:DWORD src1_sel:WORD_0
    v_lshlrev_b32_sdwa v220, 3, v238 dst_sel:DWORD dst_unused:UNUSED_PAD src0_sel:DWORD src1_sel:WORD_1
    v_lshlrev_b32_sdwa v222, 3, v239 dst_sel:DWORD dst_unused:UNUSED_PAD src0_sel:DWORD src1_sel:WORD_0
    v_lshlrev_b32_sdwa v224, 3, v239 dst_sel:DWORD dst_unused:UNUSED_PAD src0_sel:DWORD src1_sel:WORD_1
    v_cvt_pk_bf16_f32 v194, v194, v195
    v_cvt_pk_bf16_f32 v195, v196, v197
    v_cvt_pk_bf16_f32 v196, v198, v199
    v_cvt_pk_bf16_f32 v197, v200, v201
    v_mfma_f32_32x32x16_bf16 v[162:177], v[134:137], v[54:57], v[162:177]
    ds_read_b64 v[218:219], v218
    ds_read_b64 v[220:221], v220
    ds_read_b64 v[222:223], v222
    ds_read_b64 v[224:225], v224
    ds_write_b128 v216, v[194:197] offset:16384
    s_waitcnt lgkmcnt(4)
    v_smfmac_f32_16x16x64_bf16 v[82:85], v[250:253], v[226:233], v254
    v_lshlrev_b32_sdwa v226, 3, v240 dst_sel:DWORD dst_unused:UNUSED_PAD src0_sel:DWORD src1_sel:WORD_0
    v_lshlrev_b32_sdwa v228, 3, v240 dst_sel:DWORD dst_unused:UNUSED_PAD src0_sel:DWORD src1_sel:WORD_1
    v_lshlrev_b32_sdwa v230, 3, v241 dst_sel:DWORD dst_unused:UNUSED_PAD src0_sel:DWORD src1_sel:WORD_0
    v_lshlrev_b32_sdwa v232, 3, v241 dst_sel:DWORD dst_unused:UNUSED_PAD src0_sel:DWORD src1_sel:WORD_1
    v_cvt_pk_bf16_f32 v74, v74, v75
    v_cvt_pk_bf16_f32 v75, v76, v77
    v_cvt_pk_bf16_f32 v76, v78, v79
    v_cvt_pk_bf16_f32 v77, v80, v81
    v_mfma_f32_32x32x16_bf16 v[162:177], v[138:141], v[58:61], v[162:177]
    ds_read_b64 v[226:227], v226
    ds_read_b64 v[228:229], v228
    ds_read_b64 v[230:231], v230
    ds_read_b64 v[232:233], v232
    buffer_load_dwordx4 v[238:241], v1, s[12:15], s28 offen offset:1024 sc1
    buffer_store_dwordx4 v[74:77], v1, s[12:15], s3 offen offset:1024 sc1
    s_waitcnt lgkmcnt(4)
    v_smfmac_f32_16x16x64_bf16 v[82:85], v[250:253], v[218:225], v254
    s_waitcnt vmcnt(4)
    v_lshlrev_b32_sdwa v218, 3, v242 dst_sel:DWORD dst_unused:UNUSED_PAD src0_sel:DWORD src1_sel:WORD_0
    v_lshlrev_b32_sdwa v220, 3, v242 dst_sel:DWORD dst_unused:UNUSED_PAD src0_sel:DWORD src1_sel:WORD_1
    v_lshlrev_b32_sdwa v222, 3, v243 dst_sel:DWORD dst_unused:UNUSED_PAD src0_sel:DWORD src1_sel:WORD_0
    v_lshlrev_b32_sdwa v224, 3, v243 dst_sel:DWORD dst_unused:UNUSED_PAD src0_sel:DWORD src1_sel:WORD_1
    v_mfma_f32_32x32x16_bf16 v[162:177], v[142:145], v[62:65], v[162:177]
    ds_read_b64 v[218:219], v218
    ds_read_b64 v[220:221], v220
    ds_read_b64 v[222:223], v222
    ds_read_b64 v[224:225], v224
    s_waitcnt lgkmcnt(4)
    v_smfmac_f32_16x16x64_bf16 v[82:85], v[250:253], v[226:233], v254
    v_lshlrev_b32_sdwa v226, 3, v244 dst_sel:DWORD dst_unused:UNUSED_PAD src0_sel:DWORD src1_sel:WORD_0
    v_lshlrev_b32_sdwa v228, 3, v244 dst_sel:DWORD dst_unused:UNUSED_PAD src0_sel:DWORD src1_sel:WORD_1
    v_lshlrev_b32_sdwa v230, 3, v245 dst_sel:DWORD dst_unused:UNUSED_PAD src0_sel:DWORD src1_sel:WORD_0
    v_lshlrev_b32_sdwa v232, 3, v245 dst_sel:DWORD dst_unused:UNUSED_PAD src0_sel:DWORD src1_sel:WORD_1
    ds_read_b64 v[226:227], v226
    ds_read_b64 v[228:229], v228
    ds_read_b64 v[230:231], v230
    ds_read_b64 v[232:233], v232
    buffer_load_dwordx4 v[242:245], v1, s[12:15], s28 offen offset:2048 sc1
    s_waitcnt lgkmcnt(4)
    v_smfmac_f32_16x16x64_bf16 v[86:89], v[250:253], v[218:225], v254
    s_waitcnt vmcnt(4)
    v_lshlrev_b32_sdwa v218, 3, v246 dst_sel:DWORD dst_unused:UNUSED_PAD src0_sel:DWORD src1_sel:WORD_0
    v_lshlrev_b32_sdwa v220, 3, v246 dst_sel:DWORD dst_unused:UNUSED_PAD src0_sel:DWORD src1_sel:WORD_1
    v_lshlrev_b32_sdwa v222, 3, v247 dst_sel:DWORD dst_unused:UNUSED_PAD src0_sel:DWORD src1_sel:WORD_0
    v_lshlrev_b32_sdwa v224, 3, v247 dst_sel:DWORD dst_unused:UNUSED_PAD src0_sel:DWORD src1_sel:WORD_1
    v_cvt_pk_bf16_f32 v162, v162, v163
    v_cvt_pk_bf16_f32 v163, v164, v165
    v_cvt_pk_bf16_f32 v164, v166, v167
    v_cvt_pk_bf16_f32 v165, v168, v169
    ds_read_b64 v[218:219], v218
    ds_read_b64 v[220:221], v220
    ds_read_b64 v[222:223], v222
    ds_read_b64 v[224:225], v224
    ds_write_b128 v216, v[162:165] offset:17408
    s_waitcnt lgkmcnt(4)
    v_smfmac_f32_16x16x64_bf16 v[86:89], v[250:253], v[226:233], v254
    v_lshlrev_b32_sdwa v226, 3, v248 dst_sel:DWORD dst_unused:UNUSED_PAD src0_sel:DWORD src1_sel:WORD_0
    v_lshlrev_b32_sdwa v228, 3, v248 dst_sel:DWORD dst_unused:UNUSED_PAD src0_sel:DWORD src1_sel:WORD_1
    v_lshlrev_b32_sdwa v230, 3, v249 dst_sel:DWORD dst_unused:UNUSED_PAD src0_sel:DWORD src1_sel:WORD_0
    v_lshlrev_b32_sdwa v232, 3, v249 dst_sel:DWORD dst_unused:UNUSED_PAD src0_sel:DWORD src1_sel:WORD_1
    ds_read_b64 v[226:227], v226
    ds_read_b64 v[228:229], v228
    ds_read_b64 v[230:231], v230
    ds_read_b64 v[232:233], v232
    buffer_load_dwordx4 v[246:249], v1, s[12:15], s28 offen offset:3072 sc1
    s_add_u32 s28, s28, 4096
    s_add_u32 s28, s28, s46
    s_waitcnt lgkmcnt(4)
    v_smfmac_f32_16x16x64_bf16 v[86:89], v[250:253], v[218:225], v254
    s_waitcnt vmcnt(4)
    v_lshlrev_b32_sdwa v218, 3, v234 dst_sel:DWORD dst_unused:UNUSED_PAD src0_sel:DWORD src1_sel:WORD_0
    v_lshlrev_b32_sdwa v220, 3, v234 dst_sel:DWORD dst_unused:UNUSED_PAD src0_sel:DWORD src1_sel:WORD_1
    v_lshlrev_b32_sdwa v222, 3, v235 dst_sel:DWORD dst_unused:UNUSED_PAD src0_sel:DWORD src1_sel:WORD_0
    v_lshlrev_b32_sdwa v224, 3, v235 dst_sel:DWORD dst_unused:UNUSED_PAD src0_sel:DWORD src1_sel:WORD_1
    ds_read_b64 v[218:219], v218
    ds_read_b64 v[220:221], v220
    ds_read_b64 v[222:223], v222
    ds_read_b64 v[224:225], v224
    s_waitcnt lgkmcnt(4)
    v_smfmac_f32_16x16x64_bf16 v[86:89], v[250:253], v[226:233], v254
    v_lshlrev_b32_sdwa v226, 3, v236 dst_sel:DWORD dst_unused:UNUSED_PAD src0_sel:DWORD src1_sel:WORD_0
    v_lshlrev_b32_sdwa v228, 3, v236 dst_sel:DWORD dst_unused:UNUSED_PAD src0_sel:DWORD src1_sel:WORD_1
    v_lshlrev_b32_sdwa v230, 3, v237 dst_sel:DWORD dst_unused:UNUSED_PAD src0_sel:DWORD src1_sel:WORD_0
    v_lshlrev_b32_sdwa v232, 3, v237 dst_sel:DWORD dst_unused:UNUSED_PAD src0_sel:DWORD src1_sel:WORD_1
    ds_read_b64 v[226:227], v226
    ds_read_b64 v[228:229], v228
    ds_read_b64 v[230:231], v230
    ds_read_b64 v[232:233], v232
    buffer_load_dwordx4 v[234:237], v1, s[12:15], s28 offen offset:0 sc1
    s_waitcnt vmcnt(3)
    v_mov_b32 v26, s64
    v_mov_b32 v27, s65
    v_mov_b32 v28, s64
    v_mov_b32 v29, s65
    s_mov_b64 exec, 0xff
    buffer_store_dwordx4 v[26:29], v1, s[12:15], s38 offen sc1
    s_mov_b64 exec, -1
    s_add_u32 s38, s38, 128
    s_waitcnt lgkmcnt(4)
    v_smfmac_f32_16x16x64_bf16 v[90:93], v[250:253], v[218:225], v254
    s_waitcnt vmcnt(5)
    v_lshlrev_b32_sdwa v218, 3, v238 dst_sel:DWORD dst_unused:UNUSED_PAD src0_sel:DWORD src1_sel:WORD_0
    v_lshlrev_b32_sdwa v220, 3, v238 dst_sel:DWORD dst_unused:UNUSED_PAD src0_sel:DWORD src1_sel:WORD_1
    v_lshlrev_b32_sdwa v222, 3, v239 dst_sel:DWORD dst_unused:UNUSED_PAD src0_sel:DWORD src1_sel:WORD_0
    v_lshlrev_b32_sdwa v224, 3, v239 dst_sel:DWORD dst_unused:UNUSED_PAD src0_sel:DWORD src1_sel:WORD_1
    ds_read_b64 v[218:219], v218
    ds_read_b64 v[220:221], v220
    ds_read_b64 v[222:223], v222
    ds_read_b64 v[224:225], v224
    s_waitcnt lgkmcnt(4)
    v_smfmac_f32_16x16x64_bf16 v[90:93], v[250:253], v[226:233], v254
    v_lshlrev_b32_sdwa v226, 3, v240 dst_sel:DWORD dst_unused:UNUSED_PAD src0_sel:DWORD src1_sel:WORD_0
    v_lshlrev_b32_sdwa v228, 3, v240 dst_sel:DWORD dst_unused:UNUSED_PAD src0_sel:DWORD src1_sel:WORD_1
    v_lshlrev_b32_sdwa v230, 3, v241 dst_sel:DWORD dst_unused:UNUSED_PAD src0_sel:DWORD src1_sel:WORD_0
    v_lshlrev_b32_sdwa v232, 3, v241 dst_sel:DWORD dst_unused:UNUSED_PAD src0_sel:DWORD src1_sel:WORD_1
    v_cvt_pk_bf16_f32 v82, v82, v83
    v_cvt_pk_bf16_f32 v83, v84, v85
    v_cvt_pk_bf16_f32 v84, v86, v87
    v_cvt_pk_bf16_f32 v85, v88, v89
    ds_read_b64 v[226:227], v226
    ds_read_b64 v[228:229], v228
    ds_read_b64 v[230:231], v230
    ds_read_b64 v[232:233], v232
    buffer_load_dwordx4 v[238:241], v1, s[12:15], s28 offen offset:1024 sc1
    buffer_store_dwordx4 v[82:85], v1, s[12:15], s3 offen offset:2048 sc1
    s_waitcnt lgkmcnt(4)
    v_smfmac_f32_16x16x64_bf16 v[90:93], v[250:253], v[218:225], v254
    s_waitcnt vmcnt(5)
    v_lshlrev_b32_sdwa v218, 3, v242 dst_sel:DWORD dst_unused:UNUSED_PAD src0_sel:DWORD src1_sel:WORD_0
    v_lshlrev_b32_sdwa v220, 3, v242 dst_sel:DWORD dst_unused:UNUSED_PAD src0_sel:DWORD src1_sel:WORD_1
    v_lshlrev_b32_sdwa v222, 3, v243 dst_sel:DWORD dst_unused:UNUSED_PAD src0_sel:DWORD src1_sel:WORD_0
    v_lshlrev_b32_sdwa v224, 3, v243 dst_sel:DWORD dst_unused:UNUSED_PAD src0_sel:DWORD src1_sel:WORD_1
    ds_read_b64 v[218:219], v218
    ds_read_b64 v[220:221], v220
    ds_read_b64 v[222:223], v222
    ds_read_b64 v[224:225], v224
    s_waitcnt lgkmcnt(4)
    v_smfmac_f32_16x16x64_bf16 v[90:93], v[250:253], v[226:233], v254
    v_lshlrev_b32_sdwa v226, 3, v244 dst_sel:DWORD dst_unused:UNUSED_PAD src0_sel:DWORD src1_sel:WORD_0
    v_lshlrev_b32_sdwa v228, 3, v244 dst_sel:DWORD dst_unused:UNUSED_PAD src0_sel:DWORD src1_sel:WORD_1
    v_lshlrev_b32_sdwa v230, 3, v245 dst_sel:DWORD dst_unused:UNUSED_PAD src0_sel:DWORD src1_sel:WORD_0
    v_lshlrev_b32_sdwa v232, 3, v245 dst_sel:DWORD dst_unused:UNUSED_PAD src0_sel:DWORD src1_sel:WORD_1
    ds_read_b64 v[226:227], v226
    ds_read_b64 v[228:229], v228
    ds_read_b64 v[230:231], v230
    ds_read_b64 v[232:233], v232
    buffer_load_dwordx4 v[242:245], v1, s[12:15], s28 offen offset:2048 sc1
    s_waitcnt lgkmcnt(4)
    v_smfmac_f32_16x16x64_bf16 v[94:97], v[250:253], v[218:225], v254
    s_waitcnt vmcnt(5)
    v_lshlrev_b32_sdwa v218, 3, v246 dst_sel:DWORD dst_unused:UNUSED_PAD src0_sel:DWORD src1_sel:WORD_0
    v_lshlrev_b32_sdwa v220, 3, v246 dst_sel:DWORD dst_unused:UNUSED_PAD src0_sel:DWORD src1_sel:WORD_1
    v_lshlrev_b32_sdwa v222, 3, v247 dst_sel:DWORD dst_unused:UNUSED_PAD src0_sel:DWORD src1_sel:WORD_0
    v_lshlrev_b32_sdwa v224, 3, v247 dst_sel:DWORD dst_unused:UNUSED_PAD src0_sel:DWORD src1_sel:WORD_1
    ds_read_b64 v[218:219], v218
    ds_read_b64 v[220:221], v220
    ds_read_b64 v[222:223], v222
    ds_read_b64 v[224:225], v224
    s_setprio 1
    s_waitcnt lgkmcnt(4)
    v_smfmac_f32_16x16x64_bf16 v[94:97], v[250:253], v[226:233], v254
    v_lshlrev_b32_sdwa v226, 3, v248 dst_sel:DWORD dst_unused:UNUSED_PAD src0_sel:DWORD src1_sel:WORD_0
    v_lshlrev_b32_sdwa v228, 3, v248 dst_sel:DWORD dst_unused:UNUSED_PAD src0_sel:DWORD src1_sel:WORD_1
    v_lshlrev_b32_sdwa v230, 3, v249 dst_sel:DWORD dst_unused:UNUSED_PAD src0_sel:DWORD src1_sel:WORD_0
    v_lshlrev_b32_sdwa v232, 3, v249 dst_sel:DWORD dst_unused:UNUSED_PAD src0_sel:DWORD src1_sel:WORD_1
    ds_read_b64 v[226:227], v226
    ds_read_b64 v[228:229], v228
    ds_read_b64 v[230:231], v230
    ds_read_b64 v[232:233], v232
    buffer_load_dwordx4 v[246:249], v1, s[12:15], s28 offen offset:3072 sc1
    s_add_u32 s28, s28, 4096
    s_waitcnt lgkmcnt(4)
    v_smfmac_f32_16x16x64_bf16 v[94:97], v[250:253], v[218:225], v254
    s_waitcnt vmcnt(5)
    v_lshlrev_b32_sdwa v218, 3, v234 dst_sel:DWORD dst_unused:UNUSED_PAD src0_sel:DWORD src1_sel:WORD_0
    v_lshlrev_b32_sdwa v220, 3, v234 dst_sel:DWORD dst_unused:UNUSED_PAD src0_sel:DWORD src1_sel:WORD_1
    v_lshlrev_b32_sdwa v222, 3, v235 dst_sel:DWORD dst_unused:UNUSED_PAD src0_sel:DWORD src1_sel:WORD_0
    v_lshlrev_b32_sdwa v224, 3, v235 dst_sel:DWORD dst_unused:UNUSED_PAD src0_sel:DWORD src1_sel:WORD_1
    ds_read_b64 v[218:219], v218
    ds_read_b64 v[220:221], v220
    ds_read_b64 v[222:223], v222
    ds_read_b64 v[224:225], v224
    s_waitcnt lgkmcnt(4)
    v_smfmac_f32_16x16x64_bf16 v[94:97], v[250:253], v[226:233], v254
    v_lshlrev_b32_sdwa v226, 3, v236 dst_sel:DWORD dst_unused:UNUSED_PAD src0_sel:DWORD src1_sel:WORD_0
    v_lshlrev_b32_sdwa v228, 3, v236 dst_sel:DWORD dst_unused:UNUSED_PAD src0_sel:DWORD src1_sel:WORD_1
    v_lshlrev_b32_sdwa v230, 3, v237 dst_sel:DWORD dst_unused:UNUSED_PAD src0_sel:DWORD src1_sel:WORD_0
    v_lshlrev_b32_sdwa v232, 3, v237 dst_sel:DWORD dst_unused:UNUSED_PAD src0_sel:DWORD src1_sel:WORD_1
    ds_read_b64 v[226:227], v226
    ds_read_b64 v[228:229], v228
    ds_read_b64 v[230:231], v230
    ds_read_b64 v[232:233], v232
    buffer_load_dwordx4 v[234:237], v1, s[12:15], s28 offen offset:0 sc1
    s_waitcnt lgkmcnt(4)
    v_smfmac_f32_16x16x64_bf16 v[98:101], v[250:253], v[218:225], v254
    s_waitcnt vmcnt(4)
    v_lshlrev_b32_sdwa v218, 3, v238 dst_sel:DWORD dst_unused:UNUSED_PAD src0_sel:DWORD src1_sel:WORD_0
    v_lshlrev_b32_sdwa v220, 3, v238 dst_sel:DWORD dst_unused:UNUSED_PAD src0_sel:DWORD src1_sel:WORD_1
    v_lshlrev_b32_sdwa v222, 3, v239 dst_sel:DWORD dst_unused:UNUSED_PAD src0_sel:DWORD src1_sel:WORD_0
    v_lshlrev_b32_sdwa v224, 3, v239 dst_sel:DWORD dst_unused:UNUSED_PAD src0_sel:DWORD src1_sel:WORD_1
    ds_read_b64 v[218:219], v218
    ds_read_b64 v[220:221], v220
    ds_read_b64 v[222:223], v222
    ds_read_b64 v[224:225], v224
    s_waitcnt lgkmcnt(4)
    v_smfmac_f32_16x16x64_bf16 v[98:101], v[250:253], v[226:233], v254
    v_lshlrev_b32_sdwa v226, 3, v240 dst_sel:DWORD dst_unused:UNUSED_PAD src0_sel:DWORD src1_sel:WORD_0
    v_lshlrev_b32_sdwa v228, 3, v240 dst_sel:DWORD dst_unused:UNUSED_PAD src0_sel:DWORD src1_sel:WORD_1
    v_lshlrev_b32_sdwa v230, 3, v241 dst_sel:DWORD dst_unused:UNUSED_PAD src0_sel:DWORD src1_sel:WORD_0
    v_lshlrev_b32_sdwa v232, 3, v241 dst_sel:DWORD dst_unused:UNUSED_PAD src0_sel:DWORD src1_sel:WORD_1
    v_cvt_pk_bf16_f32 v90, v90, v91
    v_cvt_pk_bf16_f32 v91, v92, v93
    v_cvt_pk_bf16_f32 v92, v94, v95
    v_cvt_pk_bf16_f32 v93, v96, v97
    ds_read_b64 v[226:227], v226
    ds_read_b64 v[228:229], v228
    ds_read_b64 v[230:231], v230
    ds_read_b64 v[232:233], v232
    buffer_load_dwordx4 v[238:241], v1, s[12:15], s28 offen offset:1024 sc1
    buffer_store_dwordx4 v[90:93], v1, s[12:15], s3 offen offset:3072 sc1
    s_waitcnt lgkmcnt(4)
    v_smfmac_f32_16x16x64_bf16 v[98:101], v[250:253], v[218:225], v254
    s_waitcnt vmcnt(4)
    v_lshlrev_b32_sdwa v218, 3, v242 dst_sel:DWORD dst_unused:UNUSED_PAD src0_sel:DWORD src1_sel:WORD_0
    v_lshlrev_b32_sdwa v220, 3, v242 dst_sel:DWORD dst_unused:UNUSED_PAD src0_sel:DWORD src1_sel:WORD_1
    v_lshlrev_b32_sdwa v222, 3, v243 dst_sel:DWORD dst_unused:UNUSED_PAD src0_sel:DWORD src1_sel:WORD_0
    v_lshlrev_b32_sdwa v224, 3, v243 dst_sel:DWORD dst_unused:UNUSED_PAD src0_sel:DWORD src1_sel:WORD_1
    ds_read_b64 v[218:219], v218
    ds_read_b64 v[220:221], v220
    ds_read_b64 v[222:223], v222
    ds_read_b64 v[224:225], v224
    s_waitcnt lgkmcnt(4)
    v_smfmac_f32_16x16x64_bf16 v[98:101], v[250:253], v[226:233], v254
    v_lshlrev_b32_sdwa v226, 3, v244 dst_sel:DWORD dst_unused:UNUSED_PAD src0_sel:DWORD src1_sel:WORD_0
    v_lshlrev_b32_sdwa v228, 3, v244 dst_sel:DWORD dst_unused:UNUSED_PAD src0_sel:DWORD src1_sel:WORD_1
    v_lshlrev_b32_sdwa v230, 3, v245 dst_sel:DWORD dst_unused:UNUSED_PAD src0_sel:DWORD src1_sel:WORD_0
    v_lshlrev_b32_sdwa v232, 3, v245 dst_sel:DWORD dst_unused:UNUSED_PAD src0_sel:DWORD src1_sel:WORD_1
    ds_read_b64 v[226:227], v226
    ds_read_b64 v[228:229], v228
    ds_read_b64 v[230:231], v230
    ds_read_b64 v[232:233], v232
    buffer_load_dwordx4 v[242:245], v1, s[12:15], s28 offen offset:2048 sc1
    s_lshl_b32 s31, s24, 9
    s_add_u32 s31, s31, 16809984
    v_lshlrev_b32 v20, 3, v0
    buffer_load_dwordx2 v[18:19], v20, s[12:15], s31 offen sc1
    s_waitcnt lgkmcnt(4)
    v_smfmac_f32_16x16x64_bf16 v[102:105], v[250:253], v[218:225], v254
    s_waitcnt vmcnt(5)
    v_lshlrev_b32_sdwa v218, 3, v246 dst_sel:DWORD dst_unused:UNUSED_PAD src0_sel:DWORD src1_sel:WORD_0
    v_lshlrev_b32_sdwa v220, 3, v246 dst_sel:DWORD dst_unused:UNUSED_PAD src0_sel:DWORD src1_sel:WORD_1
    v_lshlrev_b32_sdwa v222, 3, v247 dst_sel:DWORD dst_unused:UNUSED_PAD src0_sel:DWORD src1_sel:WORD_0
    v_lshlrev_b32_sdwa v224, 3, v247 dst_sel:DWORD dst_unused:UNUSED_PAD src0_sel:DWORD src1_sel:WORD_1
    ds_read_b64 v[218:219], v218
    ds_read_b64 v[220:221], v220
    ds_read_b64 v[222:223], v222
    ds_read_b64 v[224:225], v224
    s_waitcnt lgkmcnt(4)
    v_smfmac_f32_16x16x64_bf16 v[102:105], v[250:253], v[226:233], v254
    v_lshlrev_b32_sdwa v226, 3, v248 dst_sel:DWORD dst_unused:UNUSED_PAD src0_sel:DWORD src1_sel:WORD_0
    v_lshlrev_b32_sdwa v228, 3, v248 dst_sel:DWORD dst_unused:UNUSED_PAD src0_sel:DWORD src1_sel:WORD_1
    v_lshlrev_b32_sdwa v230, 3, v249 dst_sel:DWORD dst_unused:UNUSED_PAD src0_sel:DWORD src1_sel:WORD_0
    v_lshlrev_b32_sdwa v232, 3, v249 dst_sel:DWORD dst_unused:UNUSED_PAD src0_sel:DWORD src1_sel:WORD_1
    ds_read_b64 v[226:227], v226
    ds_read_b64 v[228:229], v228
    ds_read_b64 v[230:231], v230
    ds_read_b64 v[232:233], v232
    buffer_load_dwordx4 v[246:249], v1, s[12:15], s28 offen offset:3072 sc1
    s_add_u32 s28, s28, 4096
    s_waitcnt lgkmcnt(4)
    v_smfmac_f32_16x16x64_bf16 v[102:105], v[250:253], v[218:225], v254
    s_waitcnt vmcnt(5)
    v_lshlrev_b32_sdwa v218, 3, v234 dst_sel:DWORD dst_unused:UNUSED_PAD src0_sel:DWORD src1_sel:WORD_0
    v_lshlrev_b32_sdwa v220, 3, v234 dst_sel:DWORD dst_unused:UNUSED_PAD src0_sel:DWORD src1_sel:WORD_1
    v_lshlrev_b32_sdwa v222, 3, v235 dst_sel:DWORD dst_unused:UNUSED_PAD src0_sel:DWORD src1_sel:WORD_0
    v_lshlrev_b32_sdwa v224, 3, v235 dst_sel:DWORD dst_unused:UNUSED_PAD src0_sel:DWORD src1_sel:WORD_1
    ds_read_b64 v[218:219], v218
    ds_read_b64 v[220:221], v220
    ds_read_b64 v[222:223], v222
    ds_read_b64 v[224:225], v224
    s_waitcnt lgkmcnt(4)
    v_smfmac_f32_16x16x64_bf16 v[102:105], v[250:253], v[226:233], v254
    v_lshlrev_b32_sdwa v226, 3, v236 dst_sel:DWORD dst_unused:UNUSED_PAD src0_sel:DWORD src1_sel:WORD_0
    v_lshlrev_b32_sdwa v228, 3, v236 dst_sel:DWORD dst_unused:UNUSED_PAD src0_sel:DWORD src1_sel:WORD_1
    v_lshlrev_b32_sdwa v230, 3, v237 dst_sel:DWORD dst_unused:UNUSED_PAD src0_sel:DWORD src1_sel:WORD_0
    v_lshlrev_b32_sdwa v232, 3, v237 dst_sel:DWORD dst_unused:UNUSED_PAD src0_sel:DWORD src1_sel:WORD_1
    ds_read_b64 v[226:227], v226
    ds_read_b64 v[228:229], v228
    ds_read_b64 v[230:231], v230
    ds_read_b64 v[232:233], v232
    buffer_load_dwordx4 v[234:237], v1, s[12:15], s28 offen offset:0 sc1
    s_waitcnt vmcnt(4)
    v_mov_b32 v26, s64
    v_mov_b32 v27, s65
    v_mov_b32 v28, s64
    v_mov_b32 v29, s65
    s_mov_b64 exec, 0xff
    buffer_store_dwordx4 v[26:29], v1, s[12:15], s38 offen sc1
    s_mov_b64 exec, -1
    s_waitcnt lgkmcnt(4)
    v_smfmac_f32_16x16x64_bf16 v[106:109], v[250:253], v[218:225], v254
    s_waitcnt vmcnt(6)
    v_lshlrev_b32_sdwa v218, 3, v238 dst_sel:DWORD dst_unused:UNUSED_PAD src0_sel:DWORD src1_sel:WORD_0
    v_lshlrev_b32_sdwa v220, 3, v238 dst_sel:DWORD dst_unused:UNUSED_PAD src0_sel:DWORD src1_sel:WORD_1
    v_lshlrev_b32_sdwa v222, 3, v239 dst_sel:DWORD dst_unused:UNUSED_PAD src0_sel:DWORD src1_sel:WORD_0
    v_lshlrev_b32_sdwa v224, 3, v239 dst_sel:DWORD dst_unused:UNUSED_PAD src0_sel:DWORD src1_sel:WORD_1
    ds_read_b64 v[218:219], v218
    ds_read_b64 v[220:221], v220
    ds_read_b64 v[222:223], v222
    ds_read_b64 v[224:225], v224
    v_mov_b32 v24, 0
    buffer_load_dwordx2 v[22:23], v24, s[12:15], s39 offen sc1
    s_waitcnt lgkmcnt(4)
    v_smfmac_f32_16x16x64_bf16 v[106:109], v[250:253], v[226:233], v254
    v_lshlrev_b32_sdwa v226, 3, v240 dst_sel:DWORD dst_unused:UNUSED_PAD src0_sel:DWORD src1_sel:WORD_0
    v_lshlrev_b32_sdwa v228, 3, v240 dst_sel:DWORD dst_unused:UNUSED_PAD src0_sel:DWORD src1_sel:WORD_1
    v_lshlrev_b32_sdwa v230, 3, v241 dst_sel:DWORD dst_unused:UNUSED_PAD src0_sel:DWORD src1_sel:WORD_0
    v_lshlrev_b32_sdwa v232, 3, v241 dst_sel:DWORD dst_unused:UNUSED_PAD src0_sel:DWORD src1_sel:WORD_1
    ds_read_b64 v[226:227], v226
    ds_read_b64 v[228:229], v228
    ds_read_b64 v[230:231], v230
    ds_read_b64 v[232:233], v232
    buffer_load_dwordx4 v[238:241], v1, s[12:15], s28 offen offset:1024 sc1
    s_waitcnt lgkmcnt(4)
    v_smfmac_f32_16x16x64_bf16 v[106:109], v[250:253], v[218:225], v254
    s_waitcnt vmcnt(6)
    v_lshlrev_b32_sdwa v218, 3, v242 dst_sel:DWORD dst_unused:UNUSED_PAD src0_sel:DWORD src1_sel:WORD_0
    v_lshlrev_b32_sdwa v220, 3, v242 dst_sel:DWORD dst_unused:UNUSED_PAD src0_sel:DWORD src1_sel:WORD_1
    v_lshlrev_b32_sdwa v222, 3, v243 dst_sel:DWORD dst_unused:UNUSED_PAD src0_sel:DWORD src1_sel:WORD_0
    v_lshlrev_b32_sdwa v224, 3, v243 dst_sel:DWORD dst_unused:UNUSED_PAD src0_sel:DWORD src1_sel:WORD_1
    ds_read_b64 v[218:219], v218
    ds_read_b64 v[220:221], v220
    ds_read_b64 v[222:223], v222
    ds_read_b64 v[224:225], v224
    s_waitcnt lgkmcnt(4)
    v_smfmac_f32_16x16x64_bf16 v[106:109], v[250:253], v[226:233], v254
    v_lshlrev_b32_sdwa v226, 3, v244 dst_sel:DWORD dst_unused:UNUSED_PAD src0_sel:DWORD src1_sel:WORD_0
    v_lshlrev_b32_sdwa v228, 3, v244 dst_sel:DWORD dst_unused:UNUSED_PAD src0_sel:DWORD src1_sel:WORD_1
    v_lshlrev_b32_sdwa v230, 3, v245 dst_sel:DWORD dst_unused:UNUSED_PAD src0_sel:DWORD src1_sel:WORD_0
    v_lshlrev_b32_sdwa v232, 3, v245 dst_sel:DWORD dst_unused:UNUSED_PAD src0_sel:DWORD src1_sel:WORD_1
    ds_read_b64 v[226:227], v226
    ds_read_b64 v[228:229], v228
    ds_read_b64 v[230:231], v230
    ds_read_b64 v[232:233], v232
    buffer_load_dwordx4 v[242:245], v1, s[12:15], s28 offen offset:2048 sc1
    s_setprio 0
    s_waitcnt lgkmcnt(4)
    v_smfmac_f32_16x16x64_bf16 v[110:113], v[250:253], v[218:225], v254
    s_waitcnt vmcnt(5)
    v_lshlrev_b32_sdwa v218, 3, v246 dst_sel:DWORD dst_unused:UNUSED_PAD src0_sel:DWORD src1_sel:WORD_0
    v_lshlrev_b32_sdwa v220, 3, v246 dst_sel:DWORD dst_unused:UNUSED_PAD src0_sel:DWORD src1_sel:WORD_1
    v_lshlrev_b32_sdwa v222, 3, v247 dst_sel:DWORD dst_unused:UNUSED_PAD src0_sel:DWORD src1_sel:WORD_0
    v_lshlrev_b32_sdwa v224, 3, v247 dst_sel:DWORD dst_unused:UNUSED_PAD src0_sel:DWORD src1_sel:WORD_1
    ds_read_b64 v[218:219], v218
    ds_read_b64 v[220:221], v220
    ds_read_b64 v[222:223], v222
    ds_read_b64 v[224:225], v224
    s_waitcnt lgkmcnt(4)
    v_smfmac_f32_16x16x64_bf16 v[110:113], v[250:253], v[226:233], v254
    v_lshlrev_b32_sdwa v226, 3, v248 dst_sel:DWORD dst_unused:UNUSED_PAD src0_sel:DWORD src1_sel:WORD_0
    v_lshlrev_b32_sdwa v228, 3, v248 dst_sel:DWORD dst_unused:UNUSED_PAD src0_sel:DWORD src1_sel:WORD_1
    v_lshlrev_b32_sdwa v230, 3, v249 dst_sel:DWORD dst_unused:UNUSED_PAD src0_sel:DWORD src1_sel:WORD_0
    v_lshlrev_b32_sdwa v232, 3, v249 dst_sel:DWORD dst_unused:UNUSED_PAD src0_sel:DWORD src1_sel:WORD_1
    ds_read_b64 v[226:227], v226
    ds_read_b64 v[228:229], v228
    ds_read_b64 v[230:231], v230
    ds_read_b64 v[232:233], v232
    buffer_load_dwordx4 v[246:249], v1, s[12:15], s28 offen offset:3072 sc1
    s_add_u32 s28, s28, 4096
    s_waitcnt vmcnt(3)
    v_cmp_ne_u64 vcc, s[64:65], v[22:23]
    s_cbranch_vccnz H_slow
H_back:
    s_add_u32 s39, s39, 128
    buffer_load_dwordx4 v[70:73], v1, s[12:15], s37 offen offset:0 sc1
    s_waitcnt lgkmcnt(4)
    v_smfmac_f32_16x16x64_bf16 v[110:113], v[250:253], v[218:225], v254
    s_waitcnt vmcnt(6)
    v_lshlrev_b32_sdwa v218, 3, v234 dst_sel:DWORD dst_unused:UNUSED_PAD src0_sel:DWORD src1_sel:WORD_0
    v_lshlrev_b32_sdwa v220, 3, v234 dst_sel:DWORD dst_unused:UNUSED_PAD src0_sel:DWORD src1_sel:WORD_1
    v_lshlrev_b32_sdwa v222, 3, v235 dst_sel:DWORD dst_unused:UNUSED_PAD src0_sel:DWORD src1_sel:WORD_0
    v_lshlrev_b32_sdwa v224, 3, v235 dst_sel:DWORD dst_unused:UNUSED_PAD src0_sel:DWORD src1_sel:WORD_1
    ds_read_b64 v[218:219], v218
    ds_read_b64 v[220:221], v220
    ds_read_b64 v[222:223], v222
    ds_read_b64 v[224:225], v224
    s_waitcnt lgkmcnt(4)
    v_smfmac_f32_16x16x64_bf16 v[110:113], v[250:253], v[226:233], v254
    v_lshlrev_b32_sdwa v226, 3, v236 dst_sel:DWORD dst_unused:UNUSED_PAD src0_sel:DWORD src1_sel:WORD_0
    v_lshlrev_b32_sdwa v228, 3, v236 dst_sel:DWORD dst_unused:UNUSED_PAD src0_sel:DWORD src1_sel:WORD_1
    v_lshlrev_b32_sdwa v230, 3, v237 dst_sel:DWORD dst_unused:UNUSED_PAD src0_sel:DWORD src1_sel:WORD_0
    v_lshlrev_b32_sdwa v232, 3, v237 dst_sel:DWORD dst_unused:UNUSED_PAD src0_sel:DWORD src1_sel:WORD_1
    ds_read_b64 v[226:227], v226
    ds_read_b64 v[228:229], v228
    ds_read_b64 v[230:231], v230
    ds_read_b64 v[232:233], v232
    buffer_load_dwordx4 v[234:237], v1, s[12:15], s28 offen offset:0 sc1
    s_waitcnt lgkmcnt(4)
    v_smfmac_f32_16x16x64_bf16 v[114:117], v[250:253], v[218:225], v254
    s_waitcnt vmcnt(4)
    v_lshlrev_b32_sdwa v218, 3, v238 dst_sel:DWORD dst_unused:UNUSED_PAD src0_sel:DWORD src1_sel:WORD_0
    v_lshlrev_b32_sdwa v220, 3, v238 dst_sel:DWORD dst_unused:UNUSED_PAD src0_sel:DWORD src1_sel:WORD_1
    v_lshlrev_b32_sdwa v222, 3, v239 dst_sel:DWORD dst_unused:UNUSED_PAD src0_sel:DWORD src1_sel:WORD_0
    v_lshlrev_b32_sdwa v224, 3, v239 dst_sel:DWORD dst_unused:UNUSED_PAD src0_sel:DWORD src1_sel:WORD_1
    ds_read_b64 v[218:219], v218
    ds_read_b64 v[220:221], v220
    ds_read_b64 v[222:223], v222
    ds_read_b64 v[224:225], v224
    s_waitcnt lgkmcnt(4)
    v_smfmac_f32_16x16x64_bf16 v[114:117], v[250:253], v[226:233], v254
    v_lshlrev_b32_sdwa v226, 3, v240 dst_sel:DWORD dst_unused:UNUSED_PAD src0_sel:DWORD src1_sel:WORD_0
    v_lshlrev_b32_sdwa v228, 3, v240 dst_sel:DWORD dst_unused:UNUSED_PAD src0_sel:DWORD src1_sel:WORD_1
    v_lshlrev_b32_sdwa v230, 3, v241 dst_sel:DWORD dst_unused:UNUSED_PAD src0_sel:DWORD src1_sel:WORD_0
    v_lshlrev_b32_sdwa v232, 3, v241 dst_sel:DWORD dst_unused:UNUSED_PAD src0_sel:DWORD src1_sel:WORD_1
    ds_read_b64 v[226:227], v226
    ds_read_b64 v[228:229], v228
    ds_read_b64 v[230:231], v230
    ds_read_b64 v[232:233], v232
    buffer_load_dwordx4 v[238:241], v1, s[12:15], s28 offen offset:1024 sc1
    buffer_load_dwordx4 v[78:81], v1, s[12:15], s37 offen offset:1024 sc1
    s_waitcnt lgkmcnt(4)
    v_smfmac_f32_16x16x64_bf16 v[114:117], v[250:253], v[218:225], v254
    s_waitcnt vmcnt(5)
    v_lshlrev_b32_sdwa v218, 3, v242 dst_sel:DWORD dst_unused:UNUSED_PAD src0_sel:DWORD src1_sel:WORD_0
    v_lshlrev_b32_sdwa v220, 3, v242 dst_sel:DWORD dst_unused:UNUSED_PAD src0_sel:DWORD src1_sel:WORD_1
    v_lshlrev_b32_sdwa v222, 3, v243 dst_sel:DWORD dst_unused:UNUSED_PAD src0_sel:DWORD src1_sel:WORD_0
    v_lshlrev_b32_sdwa v224, 3, v243 dst_sel:DWORD dst_unused:UNUSED_PAD src0_sel:DWORD src1_sel:WORD_1
    ds_read_b64 v[218:219], v218
    ds_read_b64 v[220:221], v220
    ds_read_b64 v[222:223], v222
    ds_read_b64 v[224:225], v224
    s_waitcnt lgkmcnt(4)
    v_smfmac_f32_16x16x64_bf16 v[114:117], v[250:253], v[226:233], v254
    v_lshlrev_b32_sdwa v226, 3, v244 dst_sel:DWORD dst_unused:UNUSED_PAD src0_sel:DWORD src1_sel:WORD_0
    v_lshlrev_b32_sdwa v228, 3, v244 dst_sel:DWORD dst_unused:UNUSED_PAD src0_sel:DWORD src1_sel:WORD_1
    v_lshlrev_b32_sdwa v230, 3, v245 dst_sel:DWORD dst_unused:UNUSED_PAD src0_sel:DWORD src1_sel:WORD_0
    v_lshlrev_b32_sdwa v232, 3, v245 dst_sel:DWORD dst_unused:UNUSED_PAD src0_sel:DWORD src1_sel:WORD_1
    ds_read_b64 v[226:227], v226
    ds_read_b64 v[228:229], v228
    ds_read_b64 v[230:231], v230
    ds_read_b64 v[232:233], v232
    buffer_load_dwordx4 v[242:245], v1, s[12:15], s28 offen offset:2048 sc1
    s_waitcnt lgkmcnt(4)
    v_smfmac_f32_16x16x64_bf16 v[118:121], v[250:253], v[218:225], v254
    s_waitcnt vmcnt(5)
    v_lshlrev_b32_sdwa v218, 3, v246 dst_sel:DWORD dst_unused:UNUSED_PAD src0_sel:DWORD src1_sel:WORD_0
    v_lshlrev_b32_sdwa v220, 3, v246 dst_sel:DWORD dst_unused:UNUSED_PAD src0_sel:DWORD src1_sel:WORD_1
    v_lshlrev_b32_sdwa v222, 3, v247 dst_sel:DWORD dst_unused:UNUSED_PAD src0_sel:DWORD src1_sel:WORD_0
    v_lshlrev_b32_sdwa v224, 3, v247 dst_sel:DWORD dst_unused:UNUSED_PAD src0_sel:DWORD src1_sel:WORD_1
    ds_read_b64 v[218:219], v218
    ds_read_b64 v[220:221], v220
    ds_read_b64 v[222:223], v222
    ds_read_b64 v[224:225], v224
    s_waitcnt lgkmcnt(4)
    v_smfmac_f32_16x16x64_bf16 v[118:121], v[250:253], v[226:233], v254
    v_lshlrev_b32_sdwa v226, 3, v248 dst_sel:DWORD dst_unused:UNUSED_PAD src0_sel:DWORD src1_sel:WORD_0
    v_lshlrev_b32_sdwa v228, 3, v248 dst_sel:DWORD dst_unused:UNUSED_PAD src0_sel:DWORD src1_sel:WORD_1
    v_lshlrev_b32_sdwa v230, 3, v249 dst_sel:DWORD dst_unused:UNUSED_PAD src0_sel:DWORD src1_sel:WORD_0
    v_lshlrev_b32_sdwa v232, 3, v249 dst_sel:DWORD dst_unused:UNUSED_PAD src0_sel:DWORD src1_sel:WORD_1
    ds_read_b64 v[226:227], v226
    ds_read_b64 v[228:229], v228
    ds_read_b64 v[230:231], v230
    ds_read_b64 v[232:233], v232
    buffer_load_dwordx4 v[246:249], v1, s[12:15], s28 offen offset:3072 sc1
    s_add_u32 s28, s28, 4096
    s_add_u32 s28, s28, s47
    s_waitcnt lgkmcnt(4)
    v_smfmac_f32_16x16x64_bf16 v[118:121], v[250:253], v[218:225], v254
    s_waitcnt vmcnt(4)
    v_lshlrev_b32_sdwa v218, 3, v234 dst_sel:DWORD dst_unused:UNUSED_PAD src0_sel:DWORD src1_sel:WORD_0
    v_lshlrev_b32_sdwa v220, 3, v234 dst_sel:DWORD dst_unused:UNUSED_PAD src0_sel:DWORD src1_sel:WORD_1
    v_lshlrev_b32_sdwa v222, 3, v235 dst_sel:DWORD dst_unused:UNUSED_PAD src0_sel:DWORD src1_sel:WORD_0
    v_lshlrev_b32_sdwa v224, 3, v235 dst_sel:DWORD dst_unused:UNUSED_PAD src0_sel:DWORD src1_sel:WORD_1
    ds_read_b64 v[218:219], v218
    ds_read_b64 v[220:221], v220
    ds_read_b64 v[222:223], v222
    ds_read_b64 v[224:225], v224
    s_waitcnt lgkmcnt(4)
    v_smfmac_f32_16x16x64_bf16 v[118:121], v[250:253], v[226:233], v254
    v_lshlrev_b32_sdwa v226, 3, v236 dst_sel:DWORD dst_unused:UNUSED_PAD src0_sel:DWORD src1_sel:WORD_0
    v_lshlrev_b32_sdwa v228, 3, v236 dst_sel:DWORD dst_unused:UNUSED_PAD src0_sel:DWORD src1_sel:WORD_1
    v_lshlrev_b32_sdwa v230, 3, v237 dst_sel:DWORD dst_unused:UNUSED_PAD src0_sel:DWORD src1_sel:WORD_0
    v_lshlrev_b32_sdwa v232, 3, v237 dst_sel:DWORD dst_unused:UNUSED_PAD src0_sel:DWORD src1_sel:WORD_1
    ds_read_b64 v[226:227], v226
    ds_read_b64 v[228:229], v228
    ds_read_b64 v[230:231], v230
    ds_read_b64 v[232:233], v232
    buffer_load_dwordx2 v[234:235], v255, s[12:15], s28 offen offset:0 sc1
    buffer_load_dwordx2 v[236:237], v255, s[12:15], s28 offen offset:512 sc1
    s_waitcnt lgkmcnt(4)
    v_smfmac_f32_16x16x64_bf16 v[122:125], v[250:253], v[218:225], v254
    s_waitcnt vmcnt(5)
    v_lshlrev_b32_sdwa v218, 3, v238 dst_sel:DWORD dst_unused:UNUSED_PAD src0_sel:DWORD src1_sel:WORD_0
    v_lshlrev_b32_sdwa v220, 3, v238 dst_sel:DWORD dst_unused:UNUSED_PAD src0_sel:DWORD src1_sel:WORD_1
    v_lshlrev_b32_sdwa v222, 3, v239 dst_sel:DWORD dst_unused:UNUSED_PAD src0_sel:DWORD src1_sel:WORD_0
    v_lshlrev_b32_sdwa v224, 3, v239 dst_sel:DWORD dst_unused:UNUSED_PAD src0_sel:DWORD src1_sel:WORD_1
    ds_read_b64 v[218:219], v218
    ds_read_b64 v[220:221], v220
    ds_read_b64 v[222:223], v222
    ds_read_b64 v[224:225], v224
    buffer_load_dwordx2 v[22:23], v24, s[12:15], s39 offen sc1
    s_waitcnt lgkmcnt(4)
    v_smfmac_f32_16x16x64_bf16 v[122:125], v[250:253], v[226:233], v254
    v_lshlrev_b32_sdwa v226, 3, v240 dst_sel:DWORD dst_unused:UNUSED_PAD src0_sel:DWORD src1_sel:WORD_0
    v_lshlrev_b32_sdwa v228, 3, v240 dst_sel:DWORD dst_unused:UNUSED_PAD src0_sel:DWORD src1_sel:WORD_1
    v_lshlrev_b32_sdwa v230, 3, v241 dst_sel:DWORD dst_unused:UNUSED_PAD src0_sel:DWORD src1_sel:WORD_0
    v_lshlrev_b32_sdwa v232, 3, v241 dst_sel:DWORD dst_unused:UNUSED_PAD src0_sel:DWORD src1_sel:WORD_1
    ds_read_b64 v[226:227], v226
    ds_read_b64 v[228:229], v228
    ds_read_b64 v[230:231], v230
    ds_read_b64 v[232:233], v232
    buffer_load_dwordx2 v[238:239], v255, s[12:15], s28 offen offset:1024 sc1
    buffer_load_dwordx2 v[240:241], v255, s[12:15], s28 offen offset:1536 sc1
    s_waitcnt lgkmcnt(4)
    v_smfmac_f32_16x16x64_bf16 v[122:125], v[250:253], v[218:225], v254
    s_waitcnt vmcnt(6)
    v_lshlrev_b32_sdwa v218, 3, v242 dst_sel:DWORD dst_unused:UNUSED_PAD src0_sel:DWORD src1_sel:WORD_0
    v_lshlrev_b32_sdwa v220, 3, v242 dst_sel:DWORD dst_unused:UNUSED_PAD src0_sel:DWORD src1_sel:WORD_1
    v_lshlrev_b32_sdwa v222, 3, v243 dst_sel:DWORD dst_unused:UNUSED_PAD src0_sel:DWORD src1_sel:WORD_0
    v_lshlrev_b32_sdwa v224, 3, v243 dst_sel:DWORD dst_unused:UNUSED_PAD src0_sel:DWORD src1_sel:WORD_1
    v_lshrrev_b32 v16, 3, v0
    v_lshlrev_b32 v16, 14, v16
    v_and_b32 v17, 7, v0
    v_lshl_add_u32 v16, v17, 4, v16
    v_lshlrev_b32 v14, 2, v0
    v_add_u32 v14, 128000, v14
    ds_read_b64 v[218:219], v218
    ds_read_b64 v[220:221], v220
    ds_read_b64 v[222:223], v222
    ds_read_b64 v[224:225], v224
    s_barrier
    s_setprio 3
    s_waitcnt lgkmcnt(4)
    v_smfmac_f32_16x16x64_bf16 v[122:125], v[250:253], v[226:233], v254
    v_lshlrev_b32_sdwa v226, 3, v244 dst_sel:DWORD dst_unused:UNUSED_PAD src0_sel:DWORD src1_sel:WORD_0
    v_lshlrev_b32_sdwa v228, 3, v244 dst_sel:DWORD dst_unused:UNUSED_PAD src0_sel:DWORD src1_sel:WORD_1
    v_lshlrev_b32_sdwa v230, 3, v245 dst_sel:DWORD dst_unused:UNUSED_PAD src0_sel:DWORD src1_sel:WORD_0
    v_lshlrev_b32_sdwa v232, 3, v245 dst_sel:DWORD dst_unused:UNUSED_PAD src0_sel:DWORD src1_sel:WORD_1
    s_lshl_b32 s29, s34, 14
    s_lshl_b32 s20, s22, 11
    s_add_u32 s29, s29, s20
    s_add_u32 s29, s29, 8388608
    s_lshl_b32 s20, s22, 8
    v_add_u32 v15, s20, v14
    v_and_b32 v12, 7, v0
    v_bfe_u32 v13, v0, 3, 1
    v_lshl_add_u32 v12, v13, 5, v12
    ds_read_b64 v[226:227], v226
    ds_read_b64 v[228:229], v228
    ds_read_b64 v[230:231], v230
    ds_read_b64 v[232:233], v232
    buffer_load_dwordx2 v[242:243], v255, s[12:15], s28 offen offset:2048 sc1
    buffer_load_dwordx2 v[244:245], v255, s[12:15], s28 offen offset:2560 sc1
    s_waitcnt lgkmcnt(4)
    v_smfmac_f32_16x16x64_bf16 v[126:129], v[250:253], v[218:225], v254
    s_waitcnt vmcnt(7)
    v_lshlrev_b32_sdwa v218, 3, v246 dst_sel:DWORD dst_unused:UNUSED_PAD src0_sel:DWORD src1_sel:WORD_0
    v_lshlrev_b32_sdwa v220, 3, v246 dst_sel:DWORD dst_unused:UNUSED_PAD src0_sel:DWORD src1_sel:WORD_1
    v_lshlrev_b32_sdwa v222, 3, v247 dst_sel:DWORD dst_unused:UNUSED_PAD src0_sel:DWORD src1_sel:WORD_0
    v_lshlrev_b32_sdwa v224, 3, v247 dst_sel:DWORD dst_unused:UNUSED_PAD src0_sel:DWORD src1_sel:WORD_1
    v_lshrrev_b32 v13, 4, v0
    v_lshl_add_u32 v12, v13, 3, v12
    s_lshl_b32 s20, s34, 6
    v_add_u32 v12, s20, v12
    v_lshlrev_b32 v12, 1, v12
    s_mov_b32 s8, s54
    s_and_b32 s9, s55, 0xffff
    s_mov_b32 s10, 32768
    s_mov_b32 s11, 0x00020000
    ds_read_b64 v[218:219], v218
    ds_read_b64 v[220:221], v220
    ds_read_b64 v[222:223], v222
    ds_read_b64 v[224:225], v224
    s_waitcnt lgkmcnt(4)
    v_smfmac_f32_16x16x64_bf16 v[126:129], v[250:253], v[226:233], v254
    v_lshlrev_b32_sdwa v226, 3, v248 dst_sel:DWORD dst_unused:UNUSED_PAD src0_sel:DWORD src1_sel:WORD_0
    v_lshlrev_b32_sdwa v228, 3, v248 dst_sel:DWORD dst_unused:UNUSED_PAD src0_sel:DWORD src1_sel:WORD_1
    v_lshlrev_b32_sdwa v230, 3, v249 dst_sel:DWORD dst_unused:UNUSED_PAD src0_sel:DWORD src1_sel:WORD_0
    v_lshlrev_b32_sdwa v232, 3, v249 dst_sel:DWORD dst_unused:UNUSED_PAD src0_sel:DWORD src1_sel:WORD_1
    ds_read_b64 v[226:227], v226
    ds_read_b64 v[228:229], v228
    ds_read_b64 v[230:231], v230
    ds_read_b64 v[232:233], v232
    buffer_load_dwordx2 v[246:247], v255, s[12:15], s28 offen offset:3072 sc1
    buffer_load_dwordx2 v[248:249], v255, s[12:15], s28 offen offset:3584 sc1
    s_add_u32 s28, s28, 4096
    s_waitcnt vmcnt(6)
    v_cmp_ne_u64 vcc, s[64:65], v[22:23]
    s_cbranch_vccnz I_slow
I_back:
    buffer_load_dwordx4 v[86:89], v1, s[12:15], s37 offen offset:2048 sc1
    buffer_load_dwordx4 v[94:97], v1, s[12:15], s37 offen offset:3072 sc1
    s_setprio 2
    s_waitcnt lgkmcnt(4)
    v_smfmac_f32_16x16x64_bf16 v[126:129], v[250:253], v[218:225], v254
    s_waitcnt vmcnt(9)
    v_lshlrev_b32_sdwa v218, 3, v234 dst_sel:DWORD dst_unused:UNUSED_PAD src0_sel:DWORD src1_sel:WORD_0
    v_lshlrev_b32_sdwa v220, 3, v234 dst_sel:DWORD dst_unused:UNUSED_PAD src0_sel:DWORD src1_sel:WORD_1
    v_lshlrev_b32_sdwa v222, 3, v235 dst_sel:DWORD dst_unused:UNUSED_PAD src0_sel:DWORD src1_sel:WORD_0
    v_lshlrev_b32_sdwa v224, 3, v235 dst_sel:DWORD dst_unused:UNUSED_PAD src0_sel:DWORD src1_sel:WORD_1
    ds_read_b64 v[218:219], v218
    ds_read_b64 v[220:221], v220
    ds_read_b64 v[222:223], v222
    ds_read_b64 v[224:225], v224
    s_mov_b32 s33, -2
    s_mov_b32 s27, 0xffff0000
    s_waitcnt lgkmcnt(4)
    v_smfmac_f32_16x16x64_bf16 v[126:129], v[250:253], v[226:233], v254
    v_lshlrev_b32_sdwa v226, 3, v236 dst_sel:DWORD dst_unused:UNUSED_PAD src0_sel:DWORD src1_sel:WORD_0
    v_lshlrev_b32_sdwa v228, 3, v236 dst_sel:DWORD dst_unused:UNUSED_PAD src0_sel:DWORD src1_sel:WORD_1
    v_lshlrev_b32_sdwa v230, 3, v237 dst_sel:DWORD dst_unused:UNUSED_PAD src0_sel:DWORD src1_sel:WORD_0
    v_lshlrev_b32_sdwa v232, 3, v237 dst_sel:DWORD dst_unused:UNUSED_PAD src0_sel:DWORD src1_sel:WORD_1
    ds_read_b64 v[226:227], v226
    ds_read_b64 v[228:229], v228
    ds_read_b64 v[230:231], v230
    ds_read_b64 v[232:233], v232
    s_waitcnt lgkmcnt(4)
    v_smfmac_f32_16x16x64_bf16 v[98:101], v[250:253], v[218:225], v254
    s_waitcnt vmcnt(6)
    v_lshlrev_b32_sdwa v218, 3, v238 dst_sel:DWORD dst_unused:UNUSED_PAD src0_sel:DWORD src1_sel:WORD_0
    v_lshlrev_b32_sdwa v220, 3, v238 dst_sel:DWORD dst_unused:UNUSED_PAD src0_sel:DWORD src1_sel:WORD_1
    v_lshlrev_b32_sdwa v222, 3, v239 dst_sel:DWORD dst_unused:UNUSED_PAD src0_sel:DWORD src1_sel:WORD_0
    v_lshlrev_b32_sdwa v224, 3, v239 dst_sel:DWORD dst_unused:UNUSED_PAD src0_sel:DWORD src1_sel:WORD_1
    ds_read_b64 v[218:219], v218
    ds_read_b64 v[220:221], v220
    ds_read_b64 v[222:223], v222
    ds_read_b64 v[224:225], v224
    s_setprio 1
    s_waitcnt lgkmcnt(4)
    v_smfmac_f32_16x16x64_bf16 v[102:105], v[250:253], v[226:233], v254
    v_lshlrev_b32_sdwa v226, 3, v240 dst_sel:DWORD dst_unused:UNUSED_PAD src0_sel:DWORD src1_sel:WORD_0
    v_lshlrev_b32_sdwa v228, 3, v240 dst_sel:DWORD dst_unused:UNUSED_PAD src0_sel:DWORD src1_sel:WORD_1
    v_lshlrev_b32_sdwa v230, 3, v241 dst_sel:DWORD dst_unused:UNUSED_PAD src0_sel:DWORD src1_sel:WORD_0
    v_lshlrev_b32_sdwa v232, 3, v241 dst_sel:DWORD dst_unused:UNUSED_PAD src0_sel:DWORD src1_sel:WORD_1
    s_waitcnt vmcnt(16)
    v_lshlrev_b32 v186, 16, v70
    v_and_b32 v187, s27, v70
    v_lshlrev_b32 v188, 16, v71
    v_and_b32 v189, s27, v71
    v_pk_add_f32 v[186:187], v[186:187], v[98:99]
    v_pk_add_f32 v[188:189], v[188:189], v[100:101]
    v_cvt_pk_bf16_f32 v162, v186, v187
    v_cvt_pk_bf16_f32 v163, v188, v189
    v_pk_max_i16 v162, v162, 0
    v_pk_max_i16 v163, v163, 0
    v_dot2_f32_bf16 v178, v162, s72, 0
    v_dot2_f32_bf16 v178, v163, s73, v178
    ds_read_b64 v[226:227], v226
    ds_read_b64 v[228:229], v228
    ds_read_b64 v[230:231], v230
    ds_read_b64 v[232:233], v232
    s_waitcnt lgkmcnt(4)
    v_smfmac_f32_16x16x64_bf16 v[106:109], v[250:253], v[218:225], v254
    s_waitcnt vmcnt(4)
    v_lshlrev_b32_sdwa v218, 3, v242 dst_sel:DWORD dst_unused:UNUSED_PAD src0_sel:DWORD src1_sel:WORD_0
    v_lshlrev_b32_sdwa v220, 3, v242 dst_sel:DWORD dst_unused:UNUSED_PAD src0_sel:DWORD src1_sel:WORD_1
    v_lshlrev_b32_sdwa v222, 3, v243 dst_sel:DWORD dst_unused:UNUSED_PAD src0_sel:DWORD src1_sel:WORD_0
    v_lshlrev_b32_sdwa v224, 3, v243 dst_sel:DWORD dst_unused:UNUSED_PAD src0_sel:DWORD src1_sel:WORD_1
    v_lshlrev_b32 v186, 16, v72
    v_and_b32 v187, s27, v72
    v_lshlrev_b32 v188, 16, v73
    v_and_b32 v189, s27, v73
    v_pk_add_f32 v[186:187], v[186:187], v[102:103]
    v_pk_add_f32 v[188:189], v[188:189], v[104:105]
    v_cvt_pk_bf16_f32 v164, v186, v187
    v_cvt_pk_bf16_f32 v165, v188, v189
    v_pk_max_i16 v164, v164, 0
    v_pk_max_i16 v165, v165, 0
    v_dot2_f32_bf16 v179, v164, s72, 0
    v_dot2_f32_bf16 v179, v165, s73, v179
    v_min_u32 v178, s33, v178
    ds_read_b64 v[218:219], v218
    ds_read_b64 v[220:221], v220
    ds_read_b64 v[222:223], v222
    ds_read_b64 v[224:225], v224
    s_waitcnt lgkmcnt(4)
    v_smfmac_f32_16x16x64_bf16 v[110:113], v[250:253], v[226:233], v254
    v_lshlrev_b32_sdwa v226, 3, v244 dst_sel:DWORD dst_unused:UNUSED_PAD src0_sel:DWORD src1_sel:WORD_0
    v_lshlrev_b32_sdwa v228, 3, v244 dst_sel:DWORD dst_unused:UNUSED_PAD src0_sel:DWORD src1_sel:WORD_1
    v_lshlrev_b32_sdwa v230, 3, v245 dst_sel:DWORD dst_unused:UNUSED_PAD src0_sel:DWORD src1_sel:WORD_0
    v_lshlrev_b32_sdwa v232, 3, v245 dst_sel:DWORD dst_unused:UNUSED_PAD src0_sel:DWORD src1_sel:WORD_1
    s_waitcnt vmcnt(13)
    v_lshlrev_b32 v186, 16, v78
    v_and_b32 v187, s27, v78
    v_lshlrev_b32 v188, 16, v79
    v_and_b32 v189, s27, v79
    v_pk_add_f32 v[186:187], v[186:187], v[106:107]
    v_pk_add_f32 v[188:189], v[188:189], v[108:109]
    v_cvt_pk_bf16_f32 v166, v186, v187
    v_cvt_pk_bf16_f32 v167, v188, v189
    v_pk_max_i16 v166, v166, 0
    v_pk_max_i16 v167, v167, 0
    v_dot2_f32_bf16 v180, v166, s72, 0
    v_dot2_f32_bf16 v180, v167, s73, v180
    v_min_u32 v179, s33, v179
    ds_read_b64 v[226:227], v226
    ds_read_b64 v[228:229], v228
    ds_read_b64 v[230:231], v230
    ds_read_b64 v[232:233], v232
    s_setprio 0
    s_waitcnt lgkmcnt(4)
    v_smfmac_f32_16x16x64_bf16 v[114:117], v[250:253], v[218:225], v254
    s_waitcnt vmcnt(2)
    v_lshlrev_b32_sdwa v218, 3, v246 dst_sel:DWORD dst_unused:UNUSED_PAD src0_sel:DWORD src1_sel:WORD_0
    v_lshlrev_b32_sdwa v220, 3, v246 dst_sel:DWORD dst_unused:UNUSED_PAD src0_sel:DWORD src1_sel:WORD_1
    v_lshlrev_b32_sdwa v222, 3, v247 dst_sel:DWORD dst_unused:UNUSED_PAD src0_sel:DWORD src1_sel:WORD_0
    v_lshlrev_b32_sdwa v224, 3, v247 dst_sel:DWORD dst_unused:UNUSED_PAD src0_sel:DWORD src1_sel:WORD_1
    v_lshlrev_b32 v186, 16, v80
    v_and_b32 v187, s27, v80
    v_lshlrev_b32 v188, 16, v81
    v_and_b32 v189, s27, v81
    v_pk_add_f32 v[186:187], v[186:187], v[110:111]
    v_pk_add_f32 v[188:189], v[188:189], v[112:113]
    v_cvt_pk_bf16_f32 v168, v186, v187
    v_cvt_pk_bf16_f32 v169, v188, v189
    v_pk_max_i16 v168, v168, 0
    v_pk_max_i16 v169, v169, 0
    v_dot2_f32_bf16 v181, v168, s72, 0
    v_dot2_f32_bf16 v181, v169, s73, v181
    v_min_u32 v180, s33, v180
    ds_read_b64 v[218:219], v218
    ds_read_b64 v[220:221], v220
    ds_read_b64 v[222:223], v222
    ds_read_b64 v[224:225], v224
    s_waitcnt lgkmcnt(4)
    v_smfmac_f32_16x16x64_bf16 v[118:121], v[250:253], v[226:233], v254
    v_lshlrev_b32_sdwa v226, 3, v248 dst_sel:DWORD dst_unused:UNUSED_PAD src0_sel:DWORD src1_sel:WORD_0
    v_lshlrev_b32_sdwa v228, 3, v248 dst_sel:DWORD dst_unused:UNUSED_PAD src0_sel:DWORD src1_sel:WORD_1
    v_lshlrev_b32_sdwa v230, 3, v249 dst_sel:DWORD dst_unused:UNUSED_PAD src0_sel:DWORD src1_sel:WORD_0
    v_lshlrev_b32_sdwa v232, 3, v249 dst_sel:DWORD dst_unused:UNUSED_PAD src0_sel:DWORD src1_sel:WORD_1
    s_waitcnt vmcnt(1)
    v_lshlrev_b32 v186, 16, v86
    v_and_b32 v187, s27, v86
    v_lshlrev_b32 v188, 16, v87
    v_and_b32 v189, s27, v87
    v_pk_add_f32 v[186:187], v[186:187], v[114:115]
    v_pk_add_f32 v[188:189], v[188:189], v[116:117]
    v_cvt_pk_bf16_f32 v170, v186, v187
    v_cvt_pk_bf16_f32 v171, v188, v189
    v_pk_max_i16 v170, v170, 0
    v_pk_max_i16 v171, v171, 0
    v_dot2_f32_bf16 v182, v170, s72, 0
    v_dot2_f32_bf16 v182, v171, s73, v182
    v_min_u32 v181, s33, v181
    ds_read_b64 v[226:227], v226
    ds_read_b64 v[228:229], v228
    ds_read_b64 v[230:231], v230
    ds_read_b64 v[232:233], v232
    buffer_store_dwordx4 v[178:181], v16, s[12:15], s75 offen sc1
    s_waitcnt lgkmcnt(4)
    v_smfmac_f32_16x16x64_bf16 v[122:125], v[250:253], v[218:225], v254
    v_lshlrev_b32 v186, 16, v88
    v_and_b32 v187, s27, v88
    v_lshlrev_b32 v188, 16, v89
    v_and_b32 v189, s27, v89
    v_pk_add_f32 v[186:187], v[186:187], v[118:119]
    v_pk_add_f32 v[188:189], v[188:189], v[120:121]
    v_cvt_pk_bf16_f32 v172, v186, v187
    v_cvt_pk_bf16_f32 v173, v188, v189
    v_pk_max_i16 v172, v172, 0
    v_pk_max_i16 v173, v173, 0
    v_dot2_f32_bf16 v183, v172, s72, 0
    v_dot2_f32_bf16 v183, v173, s73, v183
    v_min_u32 v182, s33, v182
    s_waitcnt lgkmcnt(0)
    v_smfmac_f32_16x16x64_bf16 v[126:129], v[250:253], v[226:233], v254
    s_waitcnt vmcnt(1)
    v_lshlrev_b32 v186, 16, v94
    v_and_b32 v187, s27, v94
    v_lshlrev_b32 v188, 16, v95
    v_and_b32 v189, s27, v95
    v_pk_add_f32 v[186:187], v[186:187], v[122:123]
    v_pk_add_f32 v[188:189], v[188:189], v[124:125]
    v_cvt_pk_bf16_f32 v174, v186, v187
    v_cvt_pk_bf16_f32 v175, v188, v189
    v_pk_max_i16 v174, v174, 0
    v_pk_max_i16 v175, v175, 0
    v_dot2_f32_bf16 v184, v174, s72, 0
    v_dot2_f32_bf16 v184, v175, s73, v184
    v_min_u32 v183, s33, v183
    v_lshlrev_b32 v186, 16, v96
    v_and_b32 v187, s27, v96
    v_lshlrev_b32 v188, 16, v97
    v_and_b32 v189, s27, v97
    v_pk_add_f32 v[186:187], v[186:187], v[126:127]
    v_pk_add_f32 v[188:189], v[188:189], v[128:129]
    v_cvt_pk_bf16_f32 v176, v186, v187
    v_cvt_pk_bf16_f32 v177, v188, v189
    v_pk_max_i16 v176, v176, 0
    v_pk_max_i16 v177, v177, 0
    v_dot2_f32_bf16 v185, v176, s72, 0
    v_dot2_f32_bf16 v185, v177, s73, v185
    v_min_u32 v184, s33, v184
    s_nop 1
    v_min_u32 v185, s33, v185
    buffer_store_dwordx4 v[182:185], v16, s[12:15], s75 offen offset:128 sc1
    s_mov_b32 s20, 0
    s_cmp_lg_u32 s22, 7
    s_cbranch_scc1 R_f2
    v_and_b32 v146, s27, v146
    v_and_b32 v147, s27, v147
    v_and_b32 v148, s27, v148
    v_and_b32 v149, s27, v149
    v_and_b32 v150, s27, v150
    v_and_b32 v151, s27, v151
    v_and_b32 v152, s27, v152
    v_and_b32 v153, s27, v153
    v_and_b32 v154, s27, v154
    v_and_b32 v155, s27, v155
    v_and_b32 v156, s27, v156
    v_and_b32 v157, s27, v157
    v_and_b32 v158, s27, v158
    v_and_b32 v159, s27, v159
    v_and_b32 v160, s27, v160
    v_and_b32 v161, s27, v161
    s_nop 0
    v_readlane_b32 s36, v161, 0
    v_readlane_b32 s37, v161, 1
    v_readlane_b32 s38, v161, 2
    v_readlane_b32 s39, v161, 3
    v_readlane_b32 s40, v161, 4
    v_readlane_b32 s41, v161, 5
    v_readlane_b32 s42, v161, 6
    v_readlane_b32 s43, v161, 7
    v_readlane_b32 s44, v161, 8
    v_readlane_b32 s45, v161, 9
    v_readlane_b32 s46, v161, 10
    v_readlane_b32 s47, v161, 11
    v_readlane_b32 s48, v161, 12
    v_readfirstlane_b32 s74, v160
    v_mul_f32 v210, s36, v146
    v_fmac_f32 v210, s37, v147
    v_fmac_f32 v210, s38, v148
    v_fmac_f32 v210, s39, v149
    v_fmac_f32 v210, s40, v150
    v_fmac_f32 v210, s41, v151
    v_fmac_f32 v210, s42, v152
    v_fmac_f32 v210, s43, v153
    v_fmac_f32 v210, s44, v154
    v_fmac_f32 v210, s45, v155
    v_fmac_f32 v210, s46, v156
    v_fmac_f32 v210, s47, v157
    v_fmac_f32 v210, s48, v158
    v_cvt_pk_bf16_f32 v210, v210, v210
    v_lshlrev_b32 v210, 16, v210
    v_add_f32 v210, v210, v159
    v_cvt_pk_bf16_f32 v210, v210, v210
    v_lshlrev_b32 v210, 16, v210
R_f2:
    s_waitcnt vmcnt(0)
    v_cmp_ne_u64 vcc, s[64:65], v[18:19]
    s_cbranch_vccz R_f2ok
    s_sleep 1
    buffer_load_dwordx2 v[18:19], v20, s[12:15], s31 offen sc1
    s_add_u32 s20, s20, 1
    s_cmp_lt_u32 s20, 0x8000
    s_cbranch_scc1 R_f2
R_f2ok:
    s_mov_b32 s20, 0
R_poll:
    buffer_load_dwordx4 v[2:5], v1, s[12:15], s29 offen sc1
    buffer_load_dwordx4 v[6:9], v1, s[12:15], s29 offen offset:1024 sc1
    s_add_u32 s20, s20, 1
    s_waitcnt vmcnt(0)
    v_max3_u32 v10, v2, v3, v4
    v_max3_u32 v11, v5, v6, v7
    v_max3_u32 v10, v10, v8, v9
    v_max_u32 v10, v10, v11
    v_cmp_eq_u32 vcc, -1, v10
    s_cbranch_vccz R_ok
    s_sleep 2
    s_cmp_lt_u32 s20, 0x8000
    s_cbranch_scc1 R_poll
R_ok:
    v_add_f32 v2, v2, v6
    v_add_f32 v3, v3, v7
    v_add_f32 v4, v4, v8
    v_add_f32 v5, v5, v9
    s_nop 0
    v_permlane32_swap_b32 v2, v4
    v_permlane32_swap_b32 v3, v5
    s_nop 0
    v_add_f32 v2, v2, v4
    v_add_f32 v3, v3, v5
    s_nop 1
    v_permlane16_swap_b32 v2, v3
    s_nop 0
    v_add_f32 v2, v2, v3
    ds_write_b32 v15, v2
    s_waitcnt lgkmcnt(0)
    s_barrier
    s_cmp_lg_u32 s22, 7
    s_cbranch_scc1 M_fin
    ds_read_b32 v2, v14 offset:0
    ds_read_b32 v3, v14 offset:256
    ds_read_b32 v4, v14 offset:512
    ds_read_b32 v5, v14 offset:768
    ds_read_b32 v6, v14 offset:1024
    ds_read_b32 v7, v14 offset:1280
    ds_read_b32 v8, v14 offset:1536
    ds_read_b32 v9, v14 offset:1792
    s_waitcnt lgkmcnt(0)
    v_add_f32 v2, v2, v3
    v_add_f32 v4, v4, v5
    v_add_f32 v6, v6, v7
    v_add_f32 v8, v8, v9
    v_add_f32 v2, v2, v4
    v_add_f32 v6, v6, v8
    v_add_f32 v2, v2, v6
    v_cvt_pk_bf16_f32 v2, v2, v2
    v_lshlrev_b32 v2, 16, v2
    v_add_f32 v2, s74, v2
    v_cvt_pk_bf16_f32 v2, v2, v2
    v_lshlrev_b32 v2, 16, v2
    v_add_f32 v2, v2, v210
    v_cvt_pk_bf16_f32 v2, v2, v2
    v_lshlrev_b32 v2, 16, v2
    v_mul_f32 v2, 0xbfb8aa3b, v2
    v_exp_f32 v2, v2
    s_nop 0
    v_add_f32 v2, 1.0, v2
    v_rcp_f32 v2, v2
    s_nop 0
    v_cvt_pk_bf16_f32 v2, v2, v2
    buffer_store_short v2, v12, s[8:11], 0 offen sc0 sc1
M_fin:
M_end:
    s_endpgm
L_first:
    s_waitcnt vmcnt(0)
    s_cmp_lg_u32 s22, 1
    s_cbranch_scc1 L_f2
    v_mov_b32 v130, s64
    v_mov_b32 v131, s65
    v_mov_b32 v132, s64
    v_mov_b32 v133, s65
    s_mov_b64 exec, 0xff
    buffer_store_dwordx4 v[130:133], v1, s[12:15], s38 offen sc1
    s_mov_b64 exec, -1
    s_branch L_G1
L_f2:
    v_mov_b32 v132, 0
    v_mov_b32 v130, s64
    v_mov_b32 v131, s65
    s_mov_b64 exec, 1
    buffer_store_dwordx2 v[130:131], v132, s[12:15], s38 offen sc1
    s_mov_b64 exec, -1
    s_branch L_G1
W_slow:
    s_mov_b32 s20, 0
    s_waitcnt vmcnt(63)
Q_6:
    v_cmp_ne_u64 vcc, s[64:65], v[162:163]
    s_cbranch_vccz Q_6ok
    s_sleep 1
    buffer_load_dwordx2 v[162:163], v164, s[12:15], s39 offen sc1
    s_add_u32 s20, s20, 1
    s_waitcnt vmcnt(0)
    s_cmp_lt_u32 s20, 0x8000
    s_cbranch_scc1 Q_6
Q_6ok:
    s_branch W_back
Z_slow:
    s_mov_b32 s20, 0
    s_waitcnt vmcnt(63)
Q_7:
    v_cmp_ne_u64 vcc, s[64:65], v[210:211]
    s_cbranch_vccz Q_7ok
    s_sleep 1
    buffer_load_dwordx2 v[210:211], v212, s[12:15], s29 offen sc1
    s_add_u32 s20, s20, 1
    s_waitcnt vmcnt(0)
    s_cmp_lt_u32 s20, 0x8000
    s_cbranch_scc1 Q_7
Q_7ok:
    s_branch Z_back
H_slow:
    s_mov_b32 s20, 0
    s_waitcnt vmcnt(63)
Q_8:
    v_cmp_ne_u64 vcc, s[64:65], v[22:23]
    s_cbranch_vccz Q_8ok
    s_sleep 1
    buffer_load_dwordx2 v[22:23], v24, s[12:15], s39 offen sc1
    s_add_u32 s20, s20, 1
    s_waitcnt vmcnt(0)
    s_cmp_lt_u32 s20, 0x8000
    s_cbranch_scc1 Q_8
Q_8ok:
    s_branch H_back
I_slow:
    s_mov_b32 s20, 0
    s_waitcnt vmcnt(63)
Q_9:
    v_cmp_ne_u64 vcc, s[64:65], v[22:23]
    s_cbranch_vccz Q_9ok
    s_sleep 1
    buffer_load_dwordx2 v[22:23], v24, s[12:15], s39 offen sc1
    s_add_u32 s20, s20, 1
    s_waitcnt vmcnt(0)
    s_cmp_lt_u32 s20, 0x8000
    s_cbranch_scc1 Q_9
Q_9ok:
    s_branch I_back
J_slow:
    s_mov_b32 s21, 0
J_l:
    ds_read_b32 v169, v168
    s_add_u32 s21, s21, 1
    s_waitcnt lgkmcnt(0)
    v_readfirstlane_b32 s20, v169
    s_cmp_ge_u32 s20, 8
    s_cbranch_scc1 J_back
    s_cmp_lt_u32 s21, 0x100000
    s_cbranch_scc1 J_l
    s_branch J_back
C_end:
    s_endpgm
.section .rodata,"a"
.p2align 6
.amdhsa_kernel standalone__deep_cross_wide_deep__recsys_kernel
  .amdhsa_next_free_vgpr 256
  .amdhsa_next_free_sgpr 102
  .amdhsa_accum_offset 256
  .amdhsa_group_segment_fixed_size 0
  .amdhsa_kernarg_size 96
  .amdhsa_user_sgpr_count 2
  .amdhsa_user_sgpr_kernarg_segment_ptr 1
  .amdhsa_system_sgpr_workgroup_id_x 1
.end_amdhsa_kernel
```
